```python
import torch

def _softmax(x, axis=-1):
    return torch.softmax(x, dim=axis)
def _gelu(x):
    return torch.nn.functional.gelu(x, approximate="tanh")
def _silu(x):
    return torch.nn.functional.silu(x)
def _sigmoid(x):
    return torch.sigmoid(x)
def _layernorm(x, axis=-1, eps=1e-5):
    m = x.mean(dim=axis, keepdim=True)
    v = x.var(dim=axis, keepdim=True, unbiased=False)
    return (x - m) / torch.sqrt(v + eps)
def _scatter_add(tgt, idx, src, axis=0):
    return tgt.clone().index_add_(axis, idx, src)
def _segment_sum(src, seg, n):
    out = torch.zeros((n,) + src.shape[1:], dtype=src.dtype)
    return out.index_add_(0, seg, src)
def _pad(x, pw):
    flat = tuple(v for pair in reversed(pw) for v in pair)
    return torch.nn.functional.pad(x, flat)

kernel_name = 'standalone__fused_io_aware_attn__prompt'

def setup_inputs():

    _w = (lambda a: (lambda t: t.to(torch.bfloat16) if t.is_floating_point() else t)(torch.as_tensor(a)))
    B, H, S = 2, 32, 2048
    Dh = max(1, 512 // 32)
    return {
        "q": _w((lambda *s: torch.randn(*s, dtype=torch.bfloat16) * 0.8)(B, H, S, Dh)),
        "k": _w((lambda *s: torch.randn(*s, dtype=torch.bfloat16) * 0.8)(B, H, S, Dh)),
        "v": _w((lambda *s: torch.randn(*s, dtype=torch.bfloat16) * 0.05)(B, H, S, Dh)),
    }

def reference(q, k, v):
    scale = q.shape[-1] ** -0.5
    s = torch.einsum('bhqd,bhkd->bhqk', q, k) * scale
    p = _softmax(s, axis=-1)
    return torch.einsum('bhqk,bhkd->bhqd', p, v)
```

```asm
; @launch grid=(256,1,1) block=(512,1,1) lds=139264
.amdgcn_target "amdgcn-amd-amdhsa--gfx950"
.text
.globl standalone__fused_io_aware_attn__prompt_kernel
.p2align 8
.type standalone__fused_io_aware_attn__prompt_kernel,@function
standalone__fused_io_aware_attn__prompt_kernel:
    s_load_dwordx8 s[4:11], s[0:1], 0
    v_lshrrev_b32 v134, 6, v0
    v_and_b32 v135, 63, v0
    v_readfirstlane_b32 s28, v134
    s_cmp_ge_u32 s2, 256
    s_cbranch_scc1 L_end
    v_and_b32 v136, 31, v135
    v_lshlrev_b32 v136, 5, v136
    v_lshrrev_b32 v137, 5, v135
    v_lshl_add_u32 v131, v137, 4, v136
    v_lshlrev_b32 v143, 4, v135
    s_and_b32 s34, s2, 7
    s_lshr_b32 s35, s2, 5
    s_lshl3_add_u32 s34, s35, s34
    s_lshl_b32 s29, s34, 16
    s_bfe_u32 s35, s2, 0x20003
    s_lshl3_add_u32 s35, s35, s28
    s_lshl_b32 s35, s35, 11
    s_add_u32 s30, s29, s35
    s_mov_b32 s14, 0x400000
    s_mov_b32 s15, 0x20000
    s_mov_b32 s26, 0x400000
    s_mov_b32 s27, 0x20000
    s_cmp_lt_u32 s28, 4
    s_cbranch_scc0 L_first_b
    s_waitcnt lgkmcnt(0)
    s_mov_b32 s12, s4
    s_and_b32 s13, s5, 0xffff
    buffer_load_dwordx4 v[96:99], v131, s[12:15], s30 offen nt
    s_mov_b32 s24, s6
    s_and_b32 s25, s7, 0xffff
    buffer_load_dwordx4 v[104:107], v131, s[24:27], s29 offen nt
    buffer_load_dwordx4 v[100:103], v131, s[12:15], s30 offen offset:1024 nt
    s_branch L_setup
L_first_b:
    s_and_b32 s34, s28, 1
    s_lshl_b32 s34, s34, 11
    s_add_u32 s31, s29, s34
    s_mov_b32 s18, 0x400000
    s_mov_b32 s19, 0x20000
    s_and_b32 s35, s28, 2
    s_lshl_b32 s35, s35, 15
    s_add_u32 m0, s34, s35
    s_cmp_eq_u32 s35, 0
    s_cselect_b64 vcc, -1, 0
    v_cndmask_b32 v132, v143, v131, vcc
    s_waitcnt lgkmcnt(0)
    s_cselect_b64 s[16:17], s[6:7], s[8:9]
    s_and_b32 s17, s17, 0xffff
    buffer_load_dwordx4 v132, s[16:19], s31 offen nt lds
    buffer_load_dwordx4 v132, s[16:19], s31 offen offset:1024 nt lds
    s_add_u32 m0, m0, 0x1000
    s_add_u32 s31, s31, 0x1000
L_setup:
    s_mov_b32 s20, s10
    s_and_b32 s21, s11, 0xffff
    s_mov_b32 s22, 0x400000
    s_mov_b32 s23, 0x20000
    s_mov_b32 s32, 0x3eb8aa3b
    s_mov_b32 s33, 0x3eb8aa3b
    s_mov_b32 s37, 0
    s_mov_b32 s3, 0x42340000
    v_bfe_u32 v134, v135, 2, 2
    v_lshl_add_u32 v134, v137, 3, v134
    v_lshlrev_b32 v134, 5, v134
    v_and_b32 v136, 1, v135
    v_lshl_add_u32 v134, v136, 4, v134
    v_bfe_u32 v136, v135, 1, 1
    v_lshl_add_u32 v134, v136, 3, v134
    v_add_u32 v134, 65536, v134
    v_lshlrev_b32 v136, 3, v136
    v_add_u32 v136, 131200, v136
    v_and_b32 v137, 16, v135
    v_cmp_eq_u32 vcc, 0, v137
    v_mov_b32 v137, 8192
    v_mov_b32 v133, 0xdddddddd
    v_cndmask_b32 v142, v136, v134, vcc
    v_cndmask_b32 v130, 0, v137, vcc
    v_mov_b32 v128, v143
    v_mov_b32 v129, v142
    v_mov_b64 v[32:33], 0
    v_mov_b64 v[34:35], 0
    v_mov_b64 v[36:37], 0
    v_mov_b64 v[38:39], 0
    v_mov_b64 v[40:41], 0
    v_mov_b64 v[42:43], 0
    v_mov_b64 v[44:45], 0
    v_mov_b64 v[46:47], 0
    v_mov_b64 v[48:49], 0
    v_mov_b64 v[50:51], 0
    v_mov_b64 v[52:53], 0
    v_mov_b64 v[54:55], 0
    v_mov_b64 v[56:57], 0
    v_mov_b64 v[58:59], 0
    v_mov_b64 v[60:61], 0
    v_mov_b64 v[62:63], 0
    v_mov_b32 v108, 0.5
    v_mov_b32 v109, 0
    v_mov_b64 v[110:111], 0
    v_mov_b64 v[120:121], 0
    v_mov_b64 v[122:123], 0
    v_mov_b64 v[124:125], 0
    v_mov_b64 v[126:127], 0
    s_cmp_lt_u32 s28, 4
    s_cbranch_scc0 L_loader
    s_waitcnt vmcnt(1)
L_q:
    s_setprio 3
    v_lshlrev_b32 v64, 16, v96
    v_and_b32 v65, 0xffff0000, v96
    v_lshlrev_b32 v66, 16, v97
    v_and_b32 v67, 0xffff0000, v97
    v_lshlrev_b32 v68, 16, v98
    v_and_b32 v69, 0xffff0000, v98
    v_lshlrev_b32 v70, 16, v99
    v_and_b32 v71, 0xffff0000, v99
    v_pk_mul_f32 v[64:65], v[64:65], s[32:33]
    v_pk_mul_f32 v[66:67], v[66:67], s[32:33]
    v_pk_mul_f32 v[68:69], v[68:69], s[32:33]
    v_pk_mul_f32 v[70:71], v[70:71], s[32:33]
    v_cvt_pk_bf16_f32 v96, v64, v65
    v_cvt_pk_bf16_f32 v97, v66, v67
    v_cvt_pk_bf16_f32 v98, v68, v69
    v_cvt_pk_bf16_f32 v99, v70, v71
    s_cbranch_scc0 L_qy2
    s_waitcnt vmcnt(0)
L_qy2:
    v_lshlrev_b32 v80, 16, v100
    v_and_b32 v81, 0xffff0000, v100
    v_mfma_f32_32x32x16_bf16 v[0:15], v[104:107], v[96:99], 0
    v_lshlrev_b32 v82, 16, v101
    v_and_b32 v83, 0xffff0000, v101
    v_lshlrev_b32 v84, 16, v102
    v_and_b32 v85, 0xffff0000, v102
    v_lshlrev_b32 v86, 16, v103
    v_and_b32 v87, 0xffff0000, v103
    v_pk_mul_f32 v[80:81], v[80:81], s[32:33]
    v_pk_mul_f32 v[82:83], v[82:83], s[32:33]
    v_pk_mul_f32 v[84:85], v[84:85], s[32:33]
    v_pk_mul_f32 v[86:87], v[86:87], s[32:33]
    v_cvt_pk_bf16_f32 v100, v80, v81
    v_cvt_pk_bf16_f32 v101, v82, v83
    v_max3_f32 v120, v0, v1, v2
    v_sub_f32 v120, s3, v120
    v_and_b32 v120, 0xffff0000, v120
    v_cvt_pk_bf16_f32 v102, v84, v85
    v_cvt_pk_bf16_f32 v103, v86, v87
    v_mfma_f32_32x32x16_bf16 v[0:15], v[108:111], v[120:123], v[0:15]
    s_nop 0
    v_mfma_f32_32x32x16_bf16 v[16:31], v[104:107], v[100:103], 0
    s_nop 3
    s_nop 0
    s_cbranch_scc0 L_prio_b
L_go:
    v_exp_f32 v0, v0
    v_exp_f32 v1, v1
    v_mfma_f32_32x32x16_bf16 v[64:79], v[108:111], v[120:123], 0
    v_exp_f32 v2, v2
    v_exp_f32 v3, v3
    v_exp_f32 v4, v4
    v_exp_f32 v5, v5
    v_exp_f32 v6, v6
    v_max3_f32 v124, v16, v17, v18
    v_sub_f32 v124, s3, v124
    v_and_b32 v124, 0xffff0000, v124
    v_exp_f32 v7, v7
    v_exp_f32 v8, v8
    v_mfma_f32_32x32x16_bf16 v[16:31], v[108:111], v[124:127], v[16:31]
    v_exp_f32 v9, v9
    v_exp_f32 v10, v10
    v_exp_f32 v11, v11
    s_setprio 1
    s_cbranch_scc0 L_nobar
    s_setprio 2
    s_barrier
L_nobar:
    ds_read_b64_tr_b16 v[112:113], v129 offset:0
    ds_read_b64_tr_b16 v[114:115], v129 offset:128
    v_exp_f32 v12, v12
    v_mfma_f32_32x32x16_bf16 v[80:95], v[108:111], v[124:127], 0
    ds_read_b64_tr_b16 v[116:117], v129 offset:512
    ds_read_b64_tr_b16 v[118:119], v129 offset:640
    v_exp_f32 v13, v13
    ds_read_b128 v[108:111], v128 offset:1024
    v_exp_f32 v14, v14
    v_exp_f32 v15, v15
    v_exp_f32 v16, v16
    v_exp_f32 v17, v17
    s_waitcnt lgkmcnt(3)
    v_smfmac_f32_32x32x32_bf16 v[32:47], v[112:115], v[0:7], v133
    ds_read_b64_tr_b16 v[120:121], v129 offset:1024
    v_exp_f32 v18, v18
    v_exp_f32 v19, v19
    v_exp_f32 v20, v20
    s_waitcnt lgkmcnt(2)
    v_smfmac_f32_32x32x32_bf16 v[32:47], v[116:119], v[8:15], v133
    ds_read_b64_tr_b16 v[122:123], v129 offset:1152
    v_exp_f32 v21, v21
    v_exp_f32 v22, v22
    v_exp_f32 v23, v23
    s_waitcnt lgkmcnt(2)
    v_mfma_f32_32x32x16_bf16 v[0:15], v[108:111], v[96:99], v[64:79]
    ds_read_b64_tr_b16 v[124:125], v129 offset:1536
    v_exp_f32 v24, v24
    v_exp_f32 v25, v25
    v_exp_f32 v26, v26
    v_exp_f32 v27, v27
    v_smfmac_f32_32x32x32_bf16 v[48:63], v[112:115], v[16:23], v133
    s_nop 0
    ds_read_b64_tr_b16 v[126:127], v129 offset:1664
    v_exp_f32 v28, v28
    v_exp_f32 v29, v29
    v_exp_f32 v30, v30
    v_exp_f32 v31, v31
    v_exp_f32 v0, v0
    v_exp_f32 v1, v1
    v_smfmac_f32_32x32x32_bf16 v[48:63], v[116:119], v[24:31], v133
    s_waitcnt lgkmcnt(2)
    ds_read_b128 v[104:107], v128 offset:2048
    v_exp_f32 v2, v2
    v_exp_f32 v3, v3
    v_exp_f32 v4, v4
    v_mfma_f32_32x32x16_bf16 v[16:31], v[108:111], v[100:103], v[80:95]
    ds_read_b64_tr_b16 v[112:113], v129 offset:2048
    v_exp_f32 v5, v5
    v_exp_f32 v6, v6
    v_exp_f32 v7, v7
    v_exp_f32 v8, v8
    v_exp_f32 v9, v9
    v_exp_f32 v10, v10
    v_smfmac_f32_32x32x32_bf16 v[32:47], v[120:123], v[0:7], v133
    s_cbranch_scc0 L_site2
L_back2:
    s_waitcnt lgkmcnt(2)
    ds_read_b64_tr_b16 v[114:115], v129 offset:2176
    v_exp_f32 v11, v11
    v_exp_f32 v12, v12
    v_exp_f32 v13, v13
    v_exp_f32 v14, v14
    v_exp_f32 v15, v15
    v_exp_f32 v16, v16
    v_exp_f32 v17, v17
    v_smfmac_f32_32x32x32_bf16 v[32:47], v[124:127], v[8:15], v133
    s_waitcnt lgkmcnt(2)
    ds_read_b64_tr_b16 v[116:117], v129 offset:2560
    v_exp_f32 v18, v18
    v_exp_f32 v19, v19
    v_exp_f32 v20, v20
    v_mfma_f32_32x32x16_bf16 v[0:15], v[104:107], v[96:99], v[64:79]
    ds_read_b64_tr_b16 v[118:119], v129 offset:2688
    v_exp_f32 v21, v21
    v_exp_f32 v22, v22
    v_exp_f32 v23, v23
    v_exp_f32 v24, v24
    v_exp_f32 v25, v25
    v_exp_f32 v26, v26
    v_smfmac_f32_32x32x32_bf16 v[48:63], v[120:123], v[16:23], v133
    v_exp_f32 v27, v27
    v_exp_f32 v28, v28
    v_exp_f32 v29, v29
    v_exp_f32 v30, v30
    v_exp_f32 v31, v31
    v_exp_f32 v0, v0
    v_exp_f32 v1, v1
    v_smfmac_f32_32x32x32_bf16 v[48:63], v[124:127], v[24:31], v133
    s_waitcnt lgkmcnt(2)
    ds_read_b128 v[108:111], v128 offset:3072
    v_exp_f32 v2, v2
    v_exp_f32 v3, v3
    v_exp_f32 v4, v4
    v_mfma_f32_32x32x16_bf16 v[16:31], v[104:107], v[100:103], v[80:95]
    ds_read_b64_tr_b16 v[120:121], v129 offset:3072
    v_exp_f32 v5, v5
    v_exp_f32 v6, v6
    v_exp_f32 v7, v7
    v_exp_f32 v8, v8
    v_exp_f32 v9, v9
    v_exp_f32 v10, v10
    v_smfmac_f32_32x32x32_bf16 v[32:47], v[112:115], v[0:7], v133
    s_waitcnt lgkmcnt(2)
    ds_read_b64_tr_b16 v[122:123], v129 offset:3200
    v_exp_f32 v11, v11
    v_exp_f32 v12, v12
    v_exp_f32 v13, v13
    v_exp_f32 v14, v14
    v_exp_f32 v15, v15
    v_exp_f32 v16, v16
    v_exp_f32 v17, v17
    v_smfmac_f32_32x32x32_bf16 v[32:47], v[116:119], v[8:15], v133
    s_waitcnt lgkmcnt(2)
    ds_read_b64_tr_b16 v[124:125], v129 offset:3584
    v_exp_f32 v18, v18
    v_exp_f32 v19, v19
    v_exp_f32 v20, v20
    v_mfma_f32_32x32x16_bf16 v[0:15], v[108:111], v[96:99], v[64:79]
    ds_read_b64_tr_b16 v[126:127], v129 offset:3712
    v_exp_f32 v21, v21
    v_exp_f32 v22, v22
    v_exp_f32 v23, v23
    v_exp_f32 v24, v24
    v_exp_f32 v25, v25
    v_exp_f32 v26, v26
    v_smfmac_f32_32x32x32_bf16 v[48:63], v[112:115], v[16:23], v133
    s_cbranch_scc0 L_skip5
    s_barrier
L_skip5:
    v_exp_f32 v27, v27
    v_exp_f32 v28, v28
    v_exp_f32 v29, v29
    v_exp_f32 v30, v30
    v_exp_f32 v31, v31
    v_exp_f32 v0, v0
    v_exp_f32 v1, v1
    v_smfmac_f32_32x32x32_bf16 v[48:63], v[116:119], v[24:31], v133
    s_waitcnt lgkmcnt(2)
    ds_read_b128 v[104:107], v128 offset:4096
    v_exp_f32 v2, v2
    v_exp_f32 v3, v3
    v_exp_f32 v4, v4
    v_mfma_f32_32x32x16_bf16 v[16:31], v[108:111], v[100:103], v[80:95]
    ds_read_b64_tr_b16 v[112:113], v129 offset:4096
    v_exp_f32 v5, v5
    v_exp_f32 v6, v6
    v_exp_f32 v7, v7
    v_exp_f32 v8, v8
    v_exp_f32 v9, v9
    v_exp_f32 v10, v10
    v_smfmac_f32_32x32x32_bf16 v[32:47], v[120:123], v[0:7], v133
    s_waitcnt lgkmcnt(2)
    ds_read_b64_tr_b16 v[114:115], v129 offset:4224
    v_exp_f32 v11, v11
    v_exp_f32 v12, v12
    v_exp_f32 v13, v13
    v_exp_f32 v14, v14
    v_exp_f32 v15, v15
    v_exp_f32 v16, v16
    v_exp_f32 v17, v17
    v_smfmac_f32_32x32x32_bf16 v[32:47], v[124:127], v[8:15], v133
    s_waitcnt lgkmcnt(2)
    ds_read_b64_tr_b16 v[116:117], v129 offset:4608
    v_exp_f32 v18, v18
    v_exp_f32 v19, v19
    v_exp_f32 v20, v20
    v_mfma_f32_32x32x16_bf16 v[0:15], v[104:107], v[96:99], v[64:79]
    ds_read_b64_tr_b16 v[118:119], v129 offset:4736
    v_exp_f32 v21, v21
    v_exp_f32 v22, v22
    v_exp_f32 v23, v23
    v_exp_f32 v24, v24
    v_exp_f32 v25, v25
    v_exp_f32 v26, v26
    v_smfmac_f32_32x32x32_bf16 v[48:63], v[120:123], v[16:23], v133
    s_cbranch_scc0 L_site7
L_back7:
    v_exp_f32 v27, v27
    v_exp_f32 v28, v28
    v_exp_f32 v29, v29
    v_exp_f32 v30, v30
    v_exp_f32 v31, v31
    v_exp_f32 v0, v0
    v_exp_f32 v1, v1
    v_smfmac_f32_32x32x32_bf16 v[48:63], v[124:127], v[24:31], v133
    s_waitcnt lgkmcnt(2)
    ds_read_b128 v[108:111], v128 offset:5120
    v_exp_f32 v2, v2
    v_exp_f32 v3, v3
    v_exp_f32 v4, v4
    v_mfma_f32_32x32x16_bf16 v[16:31], v[104:107], v[100:103], v[80:95]
    ds_read_b64_tr_b16 v[120:121], v129 offset:5120
    v_exp_f32 v5, v5
    v_exp_f32 v6, v6
    v_exp_f32 v7, v7
    v_exp_f32 v8, v8
    v_exp_f32 v9, v9
    v_exp_f32 v10, v10
    v_smfmac_f32_32x32x32_bf16 v[32:47], v[112:115], v[0:7], v133
    s_waitcnt lgkmcnt(2)
    ds_read_b64_tr_b16 v[122:123], v129 offset:5248
    v_exp_f32 v11, v11
    v_exp_f32 v12, v12
    v_exp_f32 v13, v13
    v_exp_f32 v14, v14
    v_exp_f32 v15, v15
    v_exp_f32 v16, v16
    v_exp_f32 v17, v17
    v_smfmac_f32_32x32x32_bf16 v[32:47], v[116:119], v[8:15], v133
    s_waitcnt lgkmcnt(2)
    ds_read_b64_tr_b16 v[124:125], v129 offset:5632
    v_exp_f32 v18, v18
    v_exp_f32 v19, v19
    v_exp_f32 v20, v20
    v_mfma_f32_32x32x16_bf16 v[0:15], v[108:111], v[96:99], v[64:79]
    ds_read_b64_tr_b16 v[126:127], v129 offset:5760
    v_exp_f32 v21, v21
    v_exp_f32 v22, v22
    v_exp_f32 v23, v23
    v_exp_f32 v24, v24
    v_exp_f32 v25, v25
    v_exp_f32 v26, v26
    v_smfmac_f32_32x32x32_bf16 v[48:63], v[112:115], v[16:23], v133
    v_exp_f32 v27, v27
    v_exp_f32 v28, v28
    v_exp_f32 v29, v29
    v_exp_f32 v30, v30
    v_exp_f32 v31, v31
    v_exp_f32 v0, v0
    v_exp_f32 v1, v1
    v_smfmac_f32_32x32x32_bf16 v[48:63], v[116:119], v[24:31], v133
    s_waitcnt lgkmcnt(2)
    ds_read_b128 v[104:107], v128 offset:6144
    v_exp_f32 v2, v2
    v_exp_f32 v3, v3
    v_exp_f32 v4, v4
    v_mfma_f32_32x32x16_bf16 v[16:31], v[108:111], v[100:103], v[80:95]
    ds_read_b64_tr_b16 v[112:113], v129 offset:6144
    v_exp_f32 v5, v5
    v_exp_f32 v6, v6
    v_exp_f32 v7, v7
    v_exp_f32 v8, v8
    v_exp_f32 v9, v9
    v_exp_f32 v10, v10
    v_smfmac_f32_32x32x32_bf16 v[32:47], v[120:123], v[0:7], v133
    s_waitcnt lgkmcnt(2)
    ds_read_b64_tr_b16 v[114:115], v129 offset:6272
    v_exp_f32 v11, v11
    v_exp_f32 v12, v12
    v_exp_f32 v13, v13
    v_exp_f32 v14, v14
    v_exp_f32 v15, v15
    v_exp_f32 v16, v16
    v_exp_f32 v17, v17
    v_smfmac_f32_32x32x32_bf16 v[32:47], v[124:127], v[8:15], v133
    s_waitcnt lgkmcnt(2)
    ds_read_b64_tr_b16 v[116:117], v129 offset:6656
    v_exp_f32 v18, v18
    v_exp_f32 v19, v19
    v_exp_f32 v20, v20
    v_mfma_f32_32x32x16_bf16 v[0:15], v[104:107], v[96:99], v[64:79]
    ds_read_b64_tr_b16 v[118:119], v129 offset:6784
    v_exp_f32 v21, v21
    v_exp_f32 v22, v22
    v_exp_f32 v23, v23
    v_exp_f32 v24, v24
    v_exp_f32 v25, v25
    v_exp_f32 v26, v26
    v_smfmac_f32_32x32x32_bf16 v[48:63], v[120:123], v[16:23], v133
    v_exp_f32 v27, v27
    v_exp_f32 v28, v28
    v_exp_f32 v29, v29
    v_exp_f32 v30, v30
    v_exp_f32 v31, v31
    v_exp_f32 v0, v0
    v_exp_f32 v1, v1
    v_smfmac_f32_32x32x32_bf16 v[48:63], v[124:127], v[24:31], v133
    s_waitcnt lgkmcnt(2)
    ds_read_b128 v[108:111], v128 offset:7168
    v_exp_f32 v2, v2
    v_exp_f32 v3, v3
    v_exp_f32 v4, v4
    v_mfma_f32_32x32x16_bf16 v[16:31], v[104:107], v[100:103], v[80:95]
    ds_read_b64_tr_b16 v[120:121], v129 offset:7168
    v_exp_f32 v5, v5
    v_exp_f32 v6, v6
    v_exp_f32 v7, v7
    v_exp_f32 v8, v8
    v_exp_f32 v9, v9
    v_exp_f32 v10, v10
    v_smfmac_f32_32x32x32_bf16 v[32:47], v[112:115], v[0:7], v133
    s_waitcnt lgkmcnt(2)
    ds_read_b64_tr_b16 v[122:123], v129 offset:7296
    v_exp_f32 v11, v11
    v_exp_f32 v12, v12
    v_exp_f32 v13, v13
    v_exp_f32 v14, v14
    v_exp_f32 v15, v15
    v_exp_f32 v16, v16
    v_exp_f32 v17, v17
    v_smfmac_f32_32x32x32_bf16 v[32:47], v[116:119], v[8:15], v133
    s_waitcnt lgkmcnt(2)
    ds_read_b64_tr_b16 v[124:125], v129 offset:7680
    v_exp_f32 v18, v18
    v_exp_f32 v19, v19
    v_exp_f32 v20, v20
    v_mfma_f32_32x32x16_bf16 v[0:15], v[108:111], v[96:99], v[64:79]
    ds_read_b64_tr_b16 v[126:127], v129 offset:7808
    v_exp_f32 v21, v21
    v_exp_f32 v22, v22
    v_exp_f32 v23, v23
    v_exp_f32 v24, v24
    v_exp_f32 v25, v25
    v_exp_f32 v26, v26
    v_smfmac_f32_32x32x32_bf16 v[48:63], v[112:115], v[16:23], v133
    s_cbranch_scc0 L_skip13
    s_barrier
L_skip13:
    v_add_u32 v129, v130, v129
    v_exp_f32 v27, v27
    v_exp_f32 v28, v28
    v_exp_f32 v29, v29
    v_exp_f32 v30, v30
    v_exp_f32 v31, v31
    v_exp_f32 v0, v0
    v_exp_f32 v1, v1
    v_smfmac_f32_32x32x32_bf16 v[48:63], v[116:119], v[24:31], v133
    s_waitcnt lgkmcnt(2)
    ds_read_b128 v[104:107], v128 offset:8192
    v_exp_f32 v2, v2
    v_exp_f32 v3, v3
    v_exp_f32 v4, v4
    v_mfma_f32_32x32x16_bf16 v[16:31], v[108:111], v[100:103], v[80:95]
    ds_read_b64_tr_b16 v[112:113], v129 offset:0
    v_exp_f32 v5, v5
    v_exp_f32 v6, v6
    v_exp_f32 v7, v7
    v_exp_f32 v8, v8
    v_exp_f32 v9, v9
    v_exp_f32 v10, v10
    v_smfmac_f32_32x32x32_bf16 v[32:47], v[120:123], v[0:7], v133
    s_waitcnt lgkmcnt(2)
    ds_read_b64_tr_b16 v[114:115], v129 offset:128
    v_exp_f32 v11, v11
    v_exp_f32 v12, v12
    v_exp_f32 v13, v13
    v_exp_f32 v14, v14
    v_exp_f32 v15, v15
    v_exp_f32 v16, v16
    v_exp_f32 v17, v17
    v_smfmac_f32_32x32x32_bf16 v[32:47], v[124:127], v[8:15], v133
    s_waitcnt lgkmcnt(2)
    ds_read_b64_tr_b16 v[116:117], v129 offset:512
    v_exp_f32 v18, v18
    v_exp_f32 v19, v19
    v_exp_f32 v20, v20
    v_mfma_f32_32x32x16_bf16 v[0:15], v[104:107], v[96:99], v[64:79]
    ds_read_b64_tr_b16 v[118:119], v129 offset:640
    v_exp_f32 v21, v21
    v_exp_f32 v22, v22
    v_exp_f32 v23, v23
    v_exp_f32 v24, v24
    v_exp_f32 v25, v25
    v_exp_f32 v26, v26
    v_smfmac_f32_32x32x32_bf16 v[48:63], v[120:123], v[16:23], v133
    v_exp_f32 v27, v27
    v_exp_f32 v28, v28
    v_exp_f32 v29, v29
    v_exp_f32 v30, v30
    v_exp_f32 v31, v31
    v_exp_f32 v0, v0
    v_exp_f32 v1, v1
    v_smfmac_f32_32x32x32_bf16 v[48:63], v[124:127], v[24:31], v133
    s_waitcnt lgkmcnt(2)
    ds_read_b128 v[108:111], v128 offset:9216
    v_exp_f32 v2, v2
    v_exp_f32 v3, v3
    v_exp_f32 v4, v4
    v_mfma_f32_32x32x16_bf16 v[16:31], v[104:107], v[100:103], v[80:95]
    ds_read_b64_tr_b16 v[120:121], v129 offset:1024
    v_exp_f32 v5, v5
    v_exp_f32 v6, v6
    v_exp_f32 v7, v7
    v_exp_f32 v8, v8
    v_exp_f32 v9, v9
    v_exp_f32 v10, v10
    v_smfmac_f32_32x32x32_bf16 v[32:47], v[112:115], v[0:7], v133
    s_waitcnt lgkmcnt(2)
    ds_read_b64_tr_b16 v[122:123], v129 offset:1152
    v_exp_f32 v11, v11
    v_exp_f32 v12, v12
    v_exp_f32 v13, v13
    v_exp_f32 v14, v14
    v_exp_f32 v15, v15
    v_exp_f32 v16, v16
    v_exp_f32 v17, v17
    v_smfmac_f32_32x32x32_bf16 v[32:47], v[116:119], v[8:15], v133
    s_waitcnt lgkmcnt(2)
    ds_read_b64_tr_b16 v[124:125], v129 offset:1536
    v_exp_f32 v18, v18
    v_exp_f32 v19, v19
    v_exp_f32 v20, v20
    v_mfma_f32_32x32x16_bf16 v[0:15], v[108:111], v[96:99], v[64:79]
    ds_read_b64_tr_b16 v[126:127], v129 offset:1664
    v_exp_f32 v21, v21
    v_exp_f32 v22, v22
    v_exp_f32 v23, v23
    v_exp_f32 v24, v24
    v_exp_f32 v25, v25
    v_exp_f32 v26, v26
    v_smfmac_f32_32x32x32_bf16 v[48:63], v[112:115], v[16:23], v133
    v_exp_f32 v27, v27
    v_exp_f32 v28, v28
    v_exp_f32 v29, v29
    v_exp_f32 v30, v30
    v_exp_f32 v31, v31
    v_exp_f32 v0, v0
    v_exp_f32 v1, v1
    v_smfmac_f32_32x32x32_bf16 v[48:63], v[116:119], v[24:31], v133
    s_waitcnt lgkmcnt(2)
    ds_read_b128 v[104:107], v128 offset:10240
    v_exp_f32 v2, v2
    v_exp_f32 v3, v3
    v_exp_f32 v4, v4
    v_mfma_f32_32x32x16_bf16 v[16:31], v[108:111], v[100:103], v[80:95]
    ds_read_b64_tr_b16 v[112:113], v129 offset:2048
    v_exp_f32 v5, v5
    v_exp_f32 v6, v6
    v_exp_f32 v7, v7
    v_exp_f32 v8, v8
    v_exp_f32 v9, v9
    v_exp_f32 v10, v10
    v_smfmac_f32_32x32x32_bf16 v[32:47], v[120:123], v[0:7], v133
    s_waitcnt lgkmcnt(2)
    ds_read_b64_tr_b16 v[114:115], v129 offset:2176
    v_exp_f32 v11, v11
    v_exp_f32 v12, v12
    v_exp_f32 v13, v13
    v_exp_f32 v14, v14
    v_exp_f32 v15, v15
    v_exp_f32 v16, v16
    v_exp_f32 v17, v17
    v_smfmac_f32_32x32x32_bf16 v[32:47], v[124:127], v[8:15], v133
    s_waitcnt lgkmcnt(2)
    ds_read_b64_tr_b16 v[116:117], v129 offset:2560
    v_exp_f32 v18, v18
    v_exp_f32 v19, v19
    v_exp_f32 v20, v20
    v_mfma_f32_32x32x16_bf16 v[0:15], v[104:107], v[96:99], v[64:79]
    ds_read_b64_tr_b16 v[118:119], v129 offset:2688
    v_exp_f32 v21, v21
    v_exp_f32 v22, v22
    v_exp_f32 v23, v23
    v_exp_f32 v24, v24
    v_exp_f32 v25, v25
    v_exp_f32 v26, v26
    v_smfmac_f32_32x32x32_bf16 v[48:63], v[120:123], v[16:23], v133
    v_exp_f32 v27, v27
    v_exp_f32 v28, v28
    v_exp_f32 v29, v29
    v_exp_f32 v30, v30
    v_exp_f32 v31, v31
    v_exp_f32 v0, v0
    v_exp_f32 v1, v1
    v_smfmac_f32_32x32x32_bf16 v[48:63], v[124:127], v[24:31], v133
    s_waitcnt lgkmcnt(2)
    ds_read_b128 v[108:111], v128 offset:11264
    v_exp_f32 v2, v2
    v_exp_f32 v3, v3
    v_exp_f32 v4, v4
    v_mfma_f32_32x32x16_bf16 v[16:31], v[104:107], v[100:103], v[80:95]
    ds_read_b64_tr_b16 v[120:121], v129 offset:3072
    v_exp_f32 v5, v5
    v_exp_f32 v6, v6
    v_exp_f32 v7, v7
    v_exp_f32 v8, v8
    v_exp_f32 v9, v9
    v_exp_f32 v10, v10
    v_smfmac_f32_32x32x32_bf16 v[32:47], v[112:115], v[0:7], v133
    s_waitcnt lgkmcnt(2)
    ds_read_b64_tr_b16 v[122:123], v129 offset:3200
    v_exp_f32 v11, v11
    v_exp_f32 v12, v12
    v_exp_f32 v13, v13
    v_exp_f32 v14, v14
    v_exp_f32 v15, v15
    v_exp_f32 v16, v16
    v_exp_f32 v17, v17
    v_smfmac_f32_32x32x32_bf16 v[32:47], v[116:119], v[8:15], v133
    s_waitcnt lgkmcnt(2)
    ds_read_b64_tr_b16 v[124:125], v129 offset:3584
    v_exp_f32 v18, v18
    v_exp_f32 v19, v19
    v_exp_f32 v20, v20
    v_mfma_f32_32x32x16_bf16 v[0:15], v[108:111], v[96:99], v[64:79]
    ds_read_b64_tr_b16 v[126:127], v129 offset:3712
    v_exp_f32 v21, v21
    v_exp_f32 v22, v22
    v_exp_f32 v23, v23
    v_exp_f32 v24, v24
    v_exp_f32 v25, v25
    v_exp_f32 v26, v26
    v_smfmac_f32_32x32x32_bf16 v[48:63], v[112:115], v[16:23], v133
    v_exp_f32 v27, v27
    v_exp_f32 v28, v28
    v_exp_f32 v29, v29
    v_exp_f32 v30, v30
    v_exp_f32 v31, v31
    v_exp_f32 v0, v0
    v_exp_f32 v1, v1
    v_smfmac_f32_32x32x32_bf16 v[48:63], v[116:119], v[24:31], v133
    s_waitcnt lgkmcnt(2)
    ds_read_b128 v[104:107], v128 offset:12288
    v_exp_f32 v2, v2
    v_exp_f32 v3, v3
    v_exp_f32 v4, v4
    v_mfma_f32_32x32x16_bf16 v[16:31], v[108:111], v[100:103], v[80:95]
    ds_read_b64_tr_b16 v[112:113], v129 offset:4096
    v_exp_f32 v5, v5
    v_exp_f32 v6, v6
    v_exp_f32 v7, v7
    v_exp_f32 v8, v8
    v_exp_f32 v9, v9
    v_exp_f32 v10, v10
    v_smfmac_f32_32x32x32_bf16 v[32:47], v[120:123], v[0:7], v133
    s_waitcnt lgkmcnt(2)
    ds_read_b64_tr_b16 v[114:115], v129 offset:4224
    v_exp_f32 v11, v11
    v_exp_f32 v12, v12
    v_exp_f32 v13, v13
    v_exp_f32 v14, v14
    v_exp_f32 v15, v15
    v_exp_f32 v16, v16
    v_exp_f32 v17, v17
    v_smfmac_f32_32x32x32_bf16 v[32:47], v[124:127], v[8:15], v133
    s_waitcnt lgkmcnt(2)
    ds_read_b64_tr_b16 v[116:117], v129 offset:4608
    v_exp_f32 v18, v18
    v_exp_f32 v19, v19
    v_exp_f32 v20, v20
    v_mfma_f32_32x32x16_bf16 v[0:15], v[104:107], v[96:99], v[64:79]
    ds_read_b64_tr_b16 v[118:119], v129 offset:4736
    v_exp_f32 v21, v21
    v_exp_f32 v22, v22
    v_exp_f32 v23, v23
    v_exp_f32 v24, v24
    v_exp_f32 v25, v25
    v_exp_f32 v26, v26
    v_smfmac_f32_32x32x32_bf16 v[48:63], v[120:123], v[16:23], v133
    v_exp_f32 v27, v27
    v_exp_f32 v28, v28
    v_exp_f32 v29, v29
    v_exp_f32 v30, v30
    v_exp_f32 v31, v31
    v_exp_f32 v0, v0
    v_exp_f32 v1, v1
    v_smfmac_f32_32x32x32_bf16 v[48:63], v[124:127], v[24:31], v133
    s_waitcnt lgkmcnt(2)
    ds_read_b128 v[108:111], v128 offset:13312
    v_exp_f32 v2, v2
    v_exp_f32 v3, v3
    v_exp_f32 v4, v4
    v_mfma_f32_32x32x16_bf16 v[16:31], v[104:107], v[100:103], v[80:95]
    ds_read_b64_tr_b16 v[120:121], v129 offset:5120
    v_exp_f32 v5, v5
    v_exp_f32 v6, v6
    v_exp_f32 v7, v7
    v_exp_f32 v8, v8
    v_exp_f32 v9, v9
    v_exp_f32 v10, v10
    v_smfmac_f32_32x32x32_bf16 v[32:47], v[112:115], v[0:7], v133
    s_waitcnt lgkmcnt(2)
    ds_read_b64_tr_b16 v[122:123], v129 offset:5248
    v_exp_f32 v11, v11
    v_exp_f32 v12, v12
    v_exp_f32 v13, v13
    v_exp_f32 v14, v14
    v_exp_f32 v15, v15
    v_exp_f32 v16, v16
    v_exp_f32 v17, v17
    v_smfmac_f32_32x32x32_bf16 v[32:47], v[116:119], v[8:15], v133
    s_waitcnt lgkmcnt(2)
    ds_read_b64_tr_b16 v[124:125], v129 offset:5632
    v_exp_f32 v18, v18
    v_exp_f32 v19, v19
    v_exp_f32 v20, v20
    v_mfma_f32_32x32x16_bf16 v[0:15], v[108:111], v[96:99], v[64:79]
    ds_read_b64_tr_b16 v[126:127], v129 offset:5760
    v_exp_f32 v21, v21
    v_exp_f32 v22, v22
    v_exp_f32 v23, v23
    v_exp_f32 v24, v24
    v_exp_f32 v25, v25
    v_exp_f32 v26, v26
    v_smfmac_f32_32x32x32_bf16 v[48:63], v[112:115], v[16:23], v133
    v_exp_f32 v27, v27
    v_exp_f32 v28, v28
    v_exp_f32 v29, v29
    v_exp_f32 v30, v30
    v_exp_f32 v31, v31
    v_exp_f32 v0, v0
    v_exp_f32 v1, v1
    v_smfmac_f32_32x32x32_bf16 v[48:63], v[116:119], v[24:31], v133
    s_waitcnt lgkmcnt(2)
    ds_read_b128 v[104:107], v128 offset:14336
    v_exp_f32 v2, v2
    v_exp_f32 v3, v3
    v_exp_f32 v4, v4
    v_mfma_f32_32x32x16_bf16 v[16:31], v[108:111], v[100:103], v[80:95]
    ds_read_b64_tr_b16 v[112:113], v129 offset:6144
    v_exp_f32 v5, v5
    v_exp_f32 v6, v6
    v_exp_f32 v7, v7
    v_exp_f32 v8, v8
    v_exp_f32 v9, v9
    v_exp_f32 v10, v10
    v_smfmac_f32_32x32x32_bf16 v[32:47], v[120:123], v[0:7], v133
    s_waitcnt lgkmcnt(2)
    ds_read_b64_tr_b16 v[114:115], v129 offset:6272
    v_exp_f32 v11, v11
    v_exp_f32 v12, v12
    v_exp_f32 v13, v13
    v_exp_f32 v14, v14
    v_exp_f32 v15, v15
    v_exp_f32 v16, v16
    v_exp_f32 v17, v17
    v_smfmac_f32_32x32x32_bf16 v[32:47], v[124:127], v[8:15], v133
    s_waitcnt lgkmcnt(2)
    ds_read_b64_tr_b16 v[116:117], v129 offset:6656
    v_exp_f32 v18, v18
    v_exp_f32 v19, v19
    v_exp_f32 v20, v20
    v_mfma_f32_32x32x16_bf16 v[0:15], v[104:107], v[96:99], v[64:79]
    ds_read_b64_tr_b16 v[118:119], v129 offset:6784
    v_exp_f32 v21, v21
    v_exp_f32 v22, v22
    v_exp_f32 v23, v23
    v_exp_f32 v24, v24
    v_exp_f32 v25, v25
    v_exp_f32 v26, v26
    v_smfmac_f32_32x32x32_bf16 v[48:63], v[120:123], v[16:23], v133
    v_exp_f32 v27, v27
    v_exp_f32 v28, v28
    v_exp_f32 v29, v29
    v_exp_f32 v30, v30
    v_exp_f32 v31, v31
    v_exp_f32 v0, v0
    v_exp_f32 v1, v1
    v_smfmac_f32_32x32x32_bf16 v[48:63], v[124:127], v[24:31], v133
    s_waitcnt lgkmcnt(2)
    ds_read_b128 v[108:111], v128 offset:15360
    v_exp_f32 v2, v2
    v_exp_f32 v3, v3
    v_exp_f32 v4, v4
    v_mfma_f32_32x32x16_bf16 v[16:31], v[104:107], v[100:103], v[80:95]
    ds_read_b64_tr_b16 v[120:121], v129 offset:7168
    v_exp_f32 v5, v5
    v_exp_f32 v6, v6
    v_exp_f32 v7, v7
    v_exp_f32 v8, v8
    v_exp_f32 v9, v9
    v_exp_f32 v10, v10
    v_smfmac_f32_32x32x32_bf16 v[32:47], v[112:115], v[0:7], v133
    s_waitcnt lgkmcnt(2)
    ds_read_b64_tr_b16 v[122:123], v129 offset:7296
    v_exp_f32 v11, v11
    v_exp_f32 v12, v12
    v_exp_f32 v13, v13
    v_exp_f32 v14, v14
    v_exp_f32 v15, v15
    v_exp_f32 v16, v16
    v_exp_f32 v17, v17
    v_smfmac_f32_32x32x32_bf16 v[32:47], v[116:119], v[8:15], v133
    s_waitcnt lgkmcnt(2)
    ds_read_b64_tr_b16 v[124:125], v129 offset:7680
    v_exp_f32 v18, v18
    v_exp_f32 v19, v19
    v_exp_f32 v20, v20
    v_mfma_f32_32x32x16_bf16 v[0:15], v[108:111], v[96:99], v[64:79]
    ds_read_b64_tr_b16 v[126:127], v129 offset:7808
    v_exp_f32 v21, v21
    v_exp_f32 v22, v22
    v_exp_f32 v23, v23
    v_exp_f32 v24, v24
    v_exp_f32 v25, v25
    v_exp_f32 v26, v26
    v_smfmac_f32_32x32x32_bf16 v[48:63], v[112:115], v[16:23], v133
    s_cbranch_scc0 L_skip29
    s_barrier
L_skip29:
    v_add_u32 v129, v130, v129
    v_exp_f32 v27, v27
    v_exp_f32 v28, v28
    v_exp_f32 v29, v29
    v_exp_f32 v30, v30
    v_exp_f32 v31, v31
    v_exp_f32 v0, v0
    v_exp_f32 v1, v1
    v_smfmac_f32_32x32x32_bf16 v[48:63], v[116:119], v[24:31], v133
    s_waitcnt lgkmcnt(2)
    ds_read_b128 v[104:107], v128 offset:16384
    v_exp_f32 v2, v2
    v_exp_f32 v3, v3
    v_exp_f32 v4, v4
    v_mfma_f32_32x32x16_bf16 v[16:31], v[108:111], v[100:103], v[80:95]
    ds_read_b64_tr_b16 v[112:113], v129 offset:0
    v_exp_f32 v5, v5
    v_exp_f32 v6, v6
    v_exp_f32 v7, v7
    v_exp_f32 v8, v8
    v_exp_f32 v9, v9
    v_exp_f32 v10, v10
    v_smfmac_f32_32x32x32_bf16 v[32:47], v[120:123], v[0:7], v133
    s_waitcnt lgkmcnt(2)
    ds_read_b64_tr_b16 v[114:115], v129 offset:128
    v_exp_f32 v11, v11
    v_exp_f32 v12, v12
    v_exp_f32 v13, v13
    v_exp_f32 v14, v14
    v_exp_f32 v15, v15
    v_exp_f32 v16, v16
    v_exp_f32 v17, v17
    v_smfmac_f32_32x32x32_bf16 v[32:47], v[124:127], v[8:15], v133
    s_waitcnt lgkmcnt(2)
    ds_read_b64_tr_b16 v[116:117], v129 offset:512
    v_exp_f32 v18, v18
    v_exp_f32 v19, v19
    v_exp_f32 v20, v20
    v_mfma_f32_32x32x16_bf16 v[0:15], v[104:107], v[96:99], v[64:79]
    ds_read_b64_tr_b16 v[118:119], v129 offset:640
    v_exp_f32 v21, v21
    v_exp_f32 v22, v22
    v_exp_f32 v23, v23
    v_exp_f32 v24, v24
    v_exp_f32 v25, v25
    v_exp_f32 v26, v26
    v_smfmac_f32_32x32x32_bf16 v[48:63], v[120:123], v[16:23], v133
    v_exp_f32 v27, v27
    v_exp_f32 v28, v28
    v_exp_f32 v29, v29
    v_exp_f32 v30, v30
    v_exp_f32 v31, v31
    v_exp_f32 v0, v0
    v_exp_f32 v1, v1
    v_smfmac_f32_32x32x32_bf16 v[48:63], v[124:127], v[24:31], v133
    s_waitcnt lgkmcnt(2)
    ds_read_b128 v[108:111], v128 offset:17408
    v_exp_f32 v2, v2
    v_exp_f32 v3, v3
    v_exp_f32 v4, v4
    v_mfma_f32_32x32x16_bf16 v[16:31], v[104:107], v[100:103], v[80:95]
    ds_read_b64_tr_b16 v[120:121], v129 offset:1024
    v_exp_f32 v5, v5
    v_exp_f32 v6, v6
    v_exp_f32 v7, v7
    v_exp_f32 v8, v8
    v_exp_f32 v9, v9
    v_exp_f32 v10, v10
    v_smfmac_f32_32x32x32_bf16 v[32:47], v[112:115], v[0:7], v133
    s_waitcnt lgkmcnt(2)
    ds_read_b64_tr_b16 v[122:123], v129 offset:1152
    v_exp_f32 v11, v11
    v_exp_f32 v12, v12
    v_exp_f32 v13, v13
    v_exp_f32 v14, v14
    v_exp_f32 v15, v15
    v_exp_f32 v16, v16
    v_exp_f32 v17, v17
    v_smfmac_f32_32x32x32_bf16 v[32:47], v[116:119], v[8:15], v133
    s_waitcnt lgkmcnt(2)
    ds_read_b64_tr_b16 v[124:125], v129 offset:1536
    v_exp_f32 v18, v18
    v_exp_f32 v19, v19
    v_exp_f32 v20, v20
    v_mfma_f32_32x32x16_bf16 v[0:15], v[108:111], v[96:99], v[64:79]
    ds_read_b64_tr_b16 v[126:127], v129 offset:1664
    v_exp_f32 v21, v21
    v_exp_f32 v22, v22
    v_exp_f32 v23, v23
    v_exp_f32 v24, v24
    v_exp_f32 v25, v25
    v_exp_f32 v26, v26
    v_smfmac_f32_32x32x32_bf16 v[48:63], v[112:115], v[16:23], v133
    v_exp_f32 v27, v27
    v_exp_f32 v28, v28
    v_exp_f32 v29, v29
    v_exp_f32 v30, v30
    v_exp_f32 v31, v31
    v_exp_f32 v0, v0
    v_exp_f32 v1, v1
    v_smfmac_f32_32x32x32_bf16 v[48:63], v[116:119], v[24:31], v133
    s_waitcnt lgkmcnt(2)
    ds_read_b128 v[104:107], v128 offset:18432
    v_exp_f32 v2, v2
    v_exp_f32 v3, v3
    v_exp_f32 v4, v4
    v_mfma_f32_32x32x16_bf16 v[16:31], v[108:111], v[100:103], v[80:95]
    ds_read_b64_tr_b16 v[112:113], v129 offset:2048
    v_exp_f32 v5, v5
    v_exp_f32 v6, v6
    v_exp_f32 v7, v7
    v_exp_f32 v8, v8
    v_exp_f32 v9, v9
    v_exp_f32 v10, v10
    v_smfmac_f32_32x32x32_bf16 v[32:47], v[120:123], v[0:7], v133
    s_waitcnt lgkmcnt(2)
    ds_read_b64_tr_b16 v[114:115], v129 offset:2176
    v_exp_f32 v11, v11
    v_exp_f32 v12, v12
    v_exp_f32 v13, v13
    v_exp_f32 v14, v14
    v_exp_f32 v15, v15
    v_exp_f32 v16, v16
    v_exp_f32 v17, v17
    v_smfmac_f32_32x32x32_bf16 v[32:47], v[124:127], v[8:15], v133
    s_waitcnt lgkmcnt(2)
    ds_read_b64_tr_b16 v[116:117], v129 offset:2560
    v_exp_f32 v18, v18
    v_exp_f32 v19, v19
    v_exp_f32 v20, v20
    v_mfma_f32_32x32x16_bf16 v[0:15], v[104:107], v[96:99], v[64:79]
    ds_read_b64_tr_b16 v[118:119], v129 offset:2688
    v_exp_f32 v21, v21
    v_exp_f32 v22, v22
    v_exp_f32 v23, v23
    v_exp_f32 v24, v24
    v_exp_f32 v25, v25
    v_exp_f32 v26, v26
    v_smfmac_f32_32x32x32_bf16 v[48:63], v[120:123], v[16:23], v133
    v_exp_f32 v27, v27
    v_exp_f32 v28, v28
    v_exp_f32 v29, v29
    v_exp_f32 v30, v30
    v_exp_f32 v31, v31
    v_exp_f32 v0, v0
    v_exp_f32 v1, v1
    v_smfmac_f32_32x32x32_bf16 v[48:63], v[124:127], v[24:31], v133
    s_waitcnt lgkmcnt(2)
    ds_read_b128 v[108:111], v128 offset:19456
    v_exp_f32 v2, v2
    v_exp_f32 v3, v3
    v_exp_f32 v4, v4
    v_mfma_f32_32x32x16_bf16 v[16:31], v[104:107], v[100:103], v[80:95]
    ds_read_b64_tr_b16 v[120:121], v129 offset:3072
    v_exp_f32 v5, v5
    v_exp_f32 v6, v6
    v_exp_f32 v7, v7
    v_exp_f32 v8, v8
    v_exp_f32 v9, v9
    v_exp_f32 v10, v10
    v_smfmac_f32_32x32x32_bf16 v[32:47], v[112:115], v[0:7], v133
    s_waitcnt lgkmcnt(2)
    ds_read_b64_tr_b16 v[122:123], v129 offset:3200
    v_exp_f32 v11, v11
    v_exp_f32 v12, v12
    v_exp_f32 v13, v13
    v_exp_f32 v14, v14
    v_exp_f32 v15, v15
    v_exp_f32 v16, v16
    v_exp_f32 v17, v17
    v_smfmac_f32_32x32x32_bf16 v[32:47], v[116:119], v[8:15], v133
    s_waitcnt lgkmcnt(2)
    ds_read_b64_tr_b16 v[124:125], v129 offset:3584
    v_exp_f32 v18, v18
    v_exp_f32 v19, v19
    v_exp_f32 v20, v20
    v_mfma_f32_32x32x16_bf16 v[0:15], v[108:111], v[96:99], v[64:79]
    ds_read_b64_tr_b16 v[126:127], v129 offset:3712
    v_exp_f32 v21, v21
    v_exp_f32 v22, v22
    v_exp_f32 v23, v23
    v_exp_f32 v24, v24
    v_exp_f32 v25, v25
    v_exp_f32 v26, v26
    v_smfmac_f32_32x32x32_bf16 v[48:63], v[112:115], v[16:23], v133
    v_exp_f32 v27, v27
    v_exp_f32 v28, v28
    v_exp_f32 v29, v29
    v_exp_f32 v30, v30
    v_exp_f32 v31, v31
    v_exp_f32 v0, v0
    v_exp_f32 v1, v1
    v_smfmac_f32_32x32x32_bf16 v[48:63], v[116:119], v[24:31], v133
    s_waitcnt lgkmcnt(2)
    ds_read_b128 v[104:107], v128 offset:20480
    v_exp_f32 v2, v2
    v_exp_f32 v3, v3
    v_exp_f32 v4, v4
    v_mfma_f32_32x32x16_bf16 v[16:31], v[108:111], v[100:103], v[80:95]
    ds_read_b64_tr_b16 v[112:113], v129 offset:4096
    v_exp_f32 v5, v5
    v_exp_f32 v6, v6
    v_exp_f32 v7, v7
    v_exp_f32 v8, v8
    v_exp_f32 v9, v9
    v_exp_f32 v10, v10
    v_smfmac_f32_32x32x32_bf16 v[32:47], v[120:123], v[0:7], v133
    s_waitcnt lgkmcnt(2)
    ds_read_b64_tr_b16 v[114:115], v129 offset:4224
    v_exp_f32 v11, v11
    v_exp_f32 v12, v12
    v_exp_f32 v13, v13
    v_exp_f32 v14, v14
    v_exp_f32 v15, v15
    v_exp_f32 v16, v16
    v_exp_f32 v17, v17
    v_smfmac_f32_32x32x32_bf16 v[32:47], v[124:127], v[8:15], v133
    s_waitcnt lgkmcnt(2)
    ds_read_b64_tr_b16 v[116:117], v129 offset:4608
    v_exp_f32 v18, v18
    v_exp_f32 v19, v19
    v_exp_f32 v20, v20
    v_mfma_f32_32x32x16_bf16 v[0:15], v[104:107], v[96:99], v[64:79]
    ds_read_b64_tr_b16 v[118:119], v129 offset:4736
    v_exp_f32 v21, v21
    v_exp_f32 v22, v22
    v_exp_f32 v23, v23
    v_exp_f32 v24, v24
    v_exp_f32 v25, v25
    v_exp_f32 v26, v26
    v_smfmac_f32_32x32x32_bf16 v[48:63], v[120:123], v[16:23], v133
    v_exp_f32 v27, v27
    v_exp_f32 v28, v28
    v_exp_f32 v29, v29
    v_exp_f32 v30, v30
    v_exp_f32 v31, v31
    v_exp_f32 v0, v0
    v_exp_f32 v1, v1
    v_smfmac_f32_32x32x32_bf16 v[48:63], v[124:127], v[24:31], v133
    s_waitcnt lgkmcnt(2)
    ds_read_b128 v[108:111], v128 offset:21504
    v_exp_f32 v2, v2
    v_exp_f32 v3, v3
    v_exp_f32 v4, v4
    v_mfma_f32_32x32x16_bf16 v[16:31], v[104:107], v[100:103], v[80:95]
    ds_read_b64_tr_b16 v[120:121], v129 offset:5120
    v_exp_f32 v5, v5
    v_exp_f32 v6, v6
    v_exp_f32 v7, v7
    v_exp_f32 v8, v8
    v_exp_f32 v9, v9
    v_exp_f32 v10, v10
    v_smfmac_f32_32x32x32_bf16 v[32:47], v[112:115], v[0:7], v133
    s_waitcnt lgkmcnt(2)
    ds_read_b64_tr_b16 v[122:123], v129 offset:5248
    v_exp_f32 v11, v11
    v_exp_f32 v12, v12
    v_exp_f32 v13, v13
    v_exp_f32 v14, v14
    v_exp_f32 v15, v15
    v_exp_f32 v16, v16
    v_exp_f32 v17, v17
    v_smfmac_f32_32x32x32_bf16 v[32:47], v[116:119], v[8:15], v133
    s_waitcnt lgkmcnt(2)
    ds_read_b64_tr_b16 v[124:125], v129 offset:5632
    v_exp_f32 v18, v18
    v_exp_f32 v19, v19
    v_exp_f32 v20, v20
    v_mfma_f32_32x32x16_bf16 v[0:15], v[108:111], v[96:99], v[64:79]
    ds_read_b64_tr_b16 v[126:127], v129 offset:5760
    v_exp_f32 v21, v21
    v_exp_f32 v22, v22
    v_exp_f32 v23, v23
    v_exp_f32 v24, v24
    v_exp_f32 v25, v25
    v_exp_f32 v26, v26
    v_smfmac_f32_32x32x32_bf16 v[48:63], v[112:115], v[16:23], v133
    v_exp_f32 v27, v27
    v_exp_f32 v28, v28
    v_exp_f32 v29, v29
    v_exp_f32 v30, v30
    v_exp_f32 v31, v31
    v_exp_f32 v0, v0
    v_exp_f32 v1, v1
    v_smfmac_f32_32x32x32_bf16 v[48:63], v[116:119], v[24:31], v133
    s_waitcnt lgkmcnt(2)
    ds_read_b128 v[104:107], v128 offset:22528
    v_exp_f32 v2, v2
    v_exp_f32 v3, v3
    v_exp_f32 v4, v4
    v_mfma_f32_32x32x16_bf16 v[16:31], v[108:111], v[100:103], v[80:95]
    ds_read_b64_tr_b16 v[112:113], v129 offset:6144
    v_exp_f32 v5, v5
    v_exp_f32 v6, v6
    v_exp_f32 v7, v7
    v_exp_f32 v8, v8
    v_exp_f32 v9, v9
    v_exp_f32 v10, v10
    v_smfmac_f32_32x32x32_bf16 v[32:47], v[120:123], v[0:7], v133
    s_waitcnt lgkmcnt(2)
    ds_read_b64_tr_b16 v[114:115], v129 offset:6272
    v_exp_f32 v11, v11
    v_exp_f32 v12, v12
    v_exp_f32 v13, v13
    v_exp_f32 v14, v14
    v_exp_f32 v15, v15
    v_exp_f32 v16, v16
    v_exp_f32 v17, v17
    v_smfmac_f32_32x32x32_bf16 v[32:47], v[124:127], v[8:15], v133
    s_waitcnt lgkmcnt(2)
    ds_read_b64_tr_b16 v[116:117], v129 offset:6656
    v_exp_f32 v18, v18
    v_exp_f32 v19, v19
    v_exp_f32 v20, v20
    v_mfma_f32_32x32x16_bf16 v[0:15], v[104:107], v[96:99], v[64:79]
    ds_read_b64_tr_b16 v[118:119], v129 offset:6784
    v_exp_f32 v21, v21
    v_exp_f32 v22, v22
    v_exp_f32 v23, v23
    v_exp_f32 v24, v24
    v_exp_f32 v25, v25
    v_exp_f32 v26, v26
    v_smfmac_f32_32x32x32_bf16 v[48:63], v[120:123], v[16:23], v133
    v_exp_f32 v27, v27
    v_exp_f32 v28, v28
    v_exp_f32 v29, v29
    v_exp_f32 v30, v30
    v_exp_f32 v31, v31
    v_exp_f32 v0, v0
    v_exp_f32 v1, v1
    v_smfmac_f32_32x32x32_bf16 v[48:63], v[124:127], v[24:31], v133
    s_waitcnt lgkmcnt(2)
    ds_read_b128 v[108:111], v128 offset:23552
    v_exp_f32 v2, v2
    v_exp_f32 v3, v3
    v_exp_f32 v4, v4
    v_mfma_f32_32x32x16_bf16 v[16:31], v[104:107], v[100:103], v[80:95]
    ds_read_b64_tr_b16 v[120:121], v129 offset:7168
    v_exp_f32 v5, v5
    v_exp_f32 v6, v6
    v_exp_f32 v7, v7
    v_exp_f32 v8, v8
    v_exp_f32 v9, v9
    v_exp_f32 v10, v10
    v_smfmac_f32_32x32x32_bf16 v[32:47], v[112:115], v[0:7], v133
    s_waitcnt lgkmcnt(2)
    ds_read_b64_tr_b16 v[122:123], v129 offset:7296
    v_exp_f32 v11, v11
    v_exp_f32 v12, v12
    v_exp_f32 v13, v13
    v_exp_f32 v14, v14
    v_exp_f32 v15, v15
    v_exp_f32 v16, v16
    v_exp_f32 v17, v17
    v_smfmac_f32_32x32x32_bf16 v[32:47], v[116:119], v[8:15], v133
    s_waitcnt lgkmcnt(2)
    ds_read_b64_tr_b16 v[124:125], v129 offset:7680
    v_exp_f32 v18, v18
    v_exp_f32 v19, v19
    v_exp_f32 v20, v20
    v_mfma_f32_32x32x16_bf16 v[0:15], v[108:111], v[96:99], v[64:79]
    ds_read_b64_tr_b16 v[126:127], v129 offset:7808
    v_exp_f32 v21, v21
    v_exp_f32 v22, v22
    v_exp_f32 v23, v23
    v_exp_f32 v24, v24
    v_exp_f32 v25, v25
    v_exp_f32 v26, v26
    v_smfmac_f32_32x32x32_bf16 v[48:63], v[112:115], v[16:23], v133
    v_add_u32 v129, v130, v129
    v_exp_f32 v27, v27
    v_exp_f32 v28, v28
    v_exp_f32 v29, v29
    v_exp_f32 v30, v30
    v_exp_f32 v31, v31
    v_exp_f32 v0, v0
    v_exp_f32 v1, v1
    v_smfmac_f32_32x32x32_bf16 v[48:63], v[116:119], v[24:31], v133
    s_waitcnt lgkmcnt(2)
    ds_read_b128 v[104:107], v128 offset:24576
    v_exp_f32 v2, v2
    v_exp_f32 v3, v3
    v_exp_f32 v4, v4
    v_mfma_f32_32x32x16_bf16 v[16:31], v[108:111], v[100:103], v[80:95]
    ds_read_b64_tr_b16 v[112:113], v129 offset:0
    v_exp_f32 v5, v5
    v_exp_f32 v6, v6
    v_exp_f32 v7, v7
    v_exp_f32 v8, v8
    v_exp_f32 v9, v9
    v_exp_f32 v10, v10
    v_smfmac_f32_32x32x32_bf16 v[32:47], v[120:123], v[0:7], v133
    s_waitcnt lgkmcnt(2)
    ds_read_b64_tr_b16 v[114:115], v129 offset:128
    v_exp_f32 v11, v11
    v_exp_f32 v12, v12
    v_exp_f32 v13, v13
    v_exp_f32 v14, v14
    v_exp_f32 v15, v15
    v_exp_f32 v16, v16
    v_exp_f32 v17, v17
    v_smfmac_f32_32x32x32_bf16 v[32:47], v[124:127], v[8:15], v133
    s_waitcnt lgkmcnt(2)
    ds_read_b64_tr_b16 v[116:117], v129 offset:512
    v_exp_f32 v18, v18
    v_exp_f32 v19, v19
    v_exp_f32 v20, v20
    v_mfma_f32_32x32x16_bf16 v[0:15], v[104:107], v[96:99], v[64:79]
    ds_read_b64_tr_b16 v[118:119], v129 offset:640
    v_exp_f32 v21, v21
    v_exp_f32 v22, v22
    v_exp_f32 v23, v23
    v_exp_f32 v24, v24
    v_exp_f32 v25, v25
    v_exp_f32 v26, v26
    v_smfmac_f32_32x32x32_bf16 v[48:63], v[120:123], v[16:23], v133
    v_exp_f32 v27, v27
    v_exp_f32 v28, v28
    v_exp_f32 v29, v29
    v_exp_f32 v30, v30
    v_exp_f32 v31, v31
    v_exp_f32 v0, v0
    v_exp_f32 v1, v1
    v_smfmac_f32_32x32x32_bf16 v[48:63], v[124:127], v[24:31], v133
    s_waitcnt lgkmcnt(2)
    ds_read_b128 v[108:111], v128 offset:25600
    v_exp_f32 v2, v2
    v_exp_f32 v3, v3
    v_exp_f32 v4, v4
    v_mfma_f32_32x32x16_bf16 v[16:31], v[104:107], v[100:103], v[80:95]
    ds_read_b64_tr_b16 v[120:121], v129 offset:1024
    v_exp_f32 v5, v5
    v_exp_f32 v6, v6
    v_exp_f32 v7, v7
    v_exp_f32 v8, v8
    v_exp_f32 v9, v9
    v_exp_f32 v10, v10
    v_smfmac_f32_32x32x32_bf16 v[32:47], v[112:115], v[0:7], v133
    s_waitcnt lgkmcnt(2)
    ds_read_b64_tr_b16 v[122:123], v129 offset:1152
    v_exp_f32 v11, v11
    v_exp_f32 v12, v12
    v_exp_f32 v13, v13
    v_exp_f32 v14, v14
    v_exp_f32 v15, v15
    v_exp_f32 v16, v16
    v_exp_f32 v17, v17
    v_smfmac_f32_32x32x32_bf16 v[32:47], v[116:119], v[8:15], v133
    s_waitcnt lgkmcnt(2)
    ds_read_b64_tr_b16 v[124:125], v129 offset:1536
    v_exp_f32 v18, v18
    v_exp_f32 v19, v19
    v_exp_f32 v20, v20
    v_mfma_f32_32x32x16_bf16 v[0:15], v[108:111], v[96:99], v[64:79]
    ds_read_b64_tr_b16 v[126:127], v129 offset:1664
    v_exp_f32 v21, v21
    v_exp_f32 v22, v22
    v_exp_f32 v23, v23
    v_exp_f32 v24, v24
    v_exp_f32 v25, v25
    v_exp_f32 v26, v26
    v_smfmac_f32_32x32x32_bf16 v[48:63], v[112:115], v[16:23], v133
    v_exp_f32 v27, v27
    v_exp_f32 v28, v28
    v_exp_f32 v29, v29
    v_exp_f32 v30, v30
    v_exp_f32 v31, v31
    v_exp_f32 v0, v0
    v_exp_f32 v1, v1
    v_smfmac_f32_32x32x32_bf16 v[48:63], v[116:119], v[24:31], v133
    s_waitcnt lgkmcnt(2)
    ds_read_b128 v[104:107], v128 offset:26624
    v_exp_f32 v2, v2
    v_exp_f32 v3, v3
    v_exp_f32 v4, v4
    v_mfma_f32_32x32x16_bf16 v[16:31], v[108:111], v[100:103], v[80:95]
    ds_read_b64_tr_b16 v[112:113], v129 offset:2048
    v_exp_f32 v5, v5
    v_exp_f32 v6, v6
    v_exp_f32 v7, v7
    v_exp_f32 v8, v8
    v_exp_f32 v9, v9
    v_exp_f32 v10, v10
    v_smfmac_f32_32x32x32_bf16 v[32:47], v[120:123], v[0:7], v133
    s_waitcnt lgkmcnt(2)
    ds_read_b64_tr_b16 v[114:115], v129 offset:2176
    v_exp_f32 v11, v11
    v_exp_f32 v12, v12
    v_exp_f32 v13, v13
    v_exp_f32 v14, v14
    v_exp_f32 v15, v15
    v_exp_f32 v16, v16
    v_exp_f32 v17, v17
    v_smfmac_f32_32x32x32_bf16 v[32:47], v[124:127], v[8:15], v133
    s_waitcnt lgkmcnt(2)
    ds_read_b64_tr_b16 v[116:117], v129 offset:2560
    v_exp_f32 v18, v18
    v_exp_f32 v19, v19
    v_exp_f32 v20, v20
    v_mfma_f32_32x32x16_bf16 v[0:15], v[104:107], v[96:99], v[64:79]
    ds_read_b64_tr_b16 v[118:119], v129 offset:2688
    v_exp_f32 v21, v21
    v_exp_f32 v22, v22
    v_exp_f32 v23, v23
    v_exp_f32 v24, v24
    v_exp_f32 v25, v25
    v_exp_f32 v26, v26
    v_smfmac_f32_32x32x32_bf16 v[48:63], v[120:123], v[16:23], v133
    v_exp_f32 v27, v27
    v_exp_f32 v28, v28
    v_exp_f32 v29, v29
    v_exp_f32 v30, v30
    v_exp_f32 v31, v31
    v_exp_f32 v0, v0
    v_exp_f32 v1, v1
    v_smfmac_f32_32x32x32_bf16 v[48:63], v[124:127], v[24:31], v133
    s_waitcnt lgkmcnt(2)
    ds_read_b128 v[108:111], v128 offset:27648
    v_exp_f32 v2, v2
    v_exp_f32 v3, v3
    v_exp_f32 v4, v4
    v_mfma_f32_32x32x16_bf16 v[16:31], v[104:107], v[100:103], v[80:95]
    ds_read_b64_tr_b16 v[120:121], v129 offset:3072
    v_exp_f32 v5, v5
    v_exp_f32 v6, v6
    v_exp_f32 v7, v7
    v_exp_f32 v8, v8
    v_exp_f32 v9, v9
    v_exp_f32 v10, v10
    v_smfmac_f32_32x32x32_bf16 v[32:47], v[112:115], v[0:7], v133
    s_waitcnt lgkmcnt(2)
    ds_read_b64_tr_b16 v[122:123], v129 offset:3200
    v_exp_f32 v11, v11
    v_exp_f32 v12, v12
    v_exp_f32 v13, v13
    v_exp_f32 v14, v14
    v_exp_f32 v15, v15
    v_exp_f32 v16, v16
    v_exp_f32 v17, v17
    v_smfmac_f32_32x32x32_bf16 v[32:47], v[116:119], v[8:15], v133
    s_waitcnt lgkmcnt(2)
    ds_read_b64_tr_b16 v[124:125], v129 offset:3584
    v_exp_f32 v18, v18
    v_exp_f32 v19, v19
    v_exp_f32 v20, v20
    v_mfma_f32_32x32x16_bf16 v[0:15], v[108:111], v[96:99], v[64:79]
    ds_read_b64_tr_b16 v[126:127], v129 offset:3712
    v_exp_f32 v21, v21
    v_exp_f32 v22, v22
    v_exp_f32 v23, v23
    v_exp_f32 v24, v24
    v_exp_f32 v25, v25
    v_exp_f32 v26, v26
    v_smfmac_f32_32x32x32_bf16 v[48:63], v[112:115], v[16:23], v133
    v_exp_f32 v27, v27
    v_exp_f32 v28, v28
    v_exp_f32 v29, v29
    v_exp_f32 v30, v30
    v_exp_f32 v31, v31
    v_exp_f32 v0, v0
    v_exp_f32 v1, v1
    v_smfmac_f32_32x32x32_bf16 v[48:63], v[116:119], v[24:31], v133
    s_waitcnt lgkmcnt(2)
    ds_read_b128 v[104:107], v128 offset:28672
    v_exp_f32 v2, v2
    v_exp_f32 v3, v3
    v_exp_f32 v4, v4
    v_mfma_f32_32x32x16_bf16 v[16:31], v[108:111], v[100:103], v[80:95]
    ds_read_b64_tr_b16 v[112:113], v129 offset:4096
    v_exp_f32 v5, v5
    v_exp_f32 v6, v6
    v_exp_f32 v7, v7
    v_exp_f32 v8, v8
    v_exp_f32 v9, v9
    v_exp_f32 v10, v10
    v_smfmac_f32_32x32x32_bf16 v[32:47], v[120:123], v[0:7], v133
    s_waitcnt lgkmcnt(2)
    ds_read_b64_tr_b16 v[114:115], v129 offset:4224
    v_exp_f32 v11, v11
    v_exp_f32 v12, v12
    v_exp_f32 v13, v13
    v_exp_f32 v14, v14
    v_exp_f32 v15, v15
    v_exp_f32 v16, v16
    v_exp_f32 v17, v17
    v_smfmac_f32_32x32x32_bf16 v[32:47], v[124:127], v[8:15], v133
    s_waitcnt lgkmcnt(2)
    ds_read_b64_tr_b16 v[116:117], v129 offset:4608
    v_exp_f32 v18, v18
    v_exp_f32 v19, v19
    v_exp_f32 v20, v20
    v_mfma_f32_32x32x16_bf16 v[0:15], v[104:107], v[96:99], v[64:79]
    ds_read_b64_tr_b16 v[118:119], v129 offset:4736
    v_exp_f32 v21, v21
    v_exp_f32 v22, v22
    v_exp_f32 v23, v23
    v_exp_f32 v24, v24
    v_exp_f32 v25, v25
    v_exp_f32 v26, v26
    v_smfmac_f32_32x32x32_bf16 v[48:63], v[120:123], v[16:23], v133
    v_exp_f32 v27, v27
    v_exp_f32 v28, v28
    v_exp_f32 v29, v29
    v_exp_f32 v30, v30
    v_exp_f32 v31, v31
    v_exp_f32 v0, v0
    v_exp_f32 v1, v1
    v_smfmac_f32_32x32x32_bf16 v[48:63], v[124:127], v[24:31], v133
    s_waitcnt lgkmcnt(2)
    ds_read_b128 v[108:111], v128 offset:29696
    v_exp_f32 v2, v2
    v_exp_f32 v3, v3
    v_exp_f32 v4, v4
    v_mfma_f32_32x32x16_bf16 v[16:31], v[104:107], v[100:103], v[80:95]
    ds_read_b64_tr_b16 v[120:121], v129 offset:5120
    v_exp_f32 v5, v5
    v_exp_f32 v6, v6
    v_exp_f32 v7, v7
    v_exp_f32 v8, v8
    v_exp_f32 v9, v9
    v_exp_f32 v10, v10
    v_smfmac_f32_32x32x32_bf16 v[32:47], v[112:115], v[0:7], v133
    s_waitcnt lgkmcnt(2)
    ds_read_b64_tr_b16 v[122:123], v129 offset:5248
    v_exp_f32 v11, v11
    v_exp_f32 v12, v12
    v_exp_f32 v13, v13
    v_exp_f32 v14, v14
    v_exp_f32 v15, v15
    v_exp_f32 v16, v16
    v_exp_f32 v17, v17
    v_smfmac_f32_32x32x32_bf16 v[32:47], v[116:119], v[8:15], v133
    s_waitcnt lgkmcnt(2)
    ds_read_b64_tr_b16 v[124:125], v129 offset:5632
    v_exp_f32 v18, v18
    v_exp_f32 v19, v19
    v_exp_f32 v20, v20
    v_mfma_f32_32x32x16_bf16 v[0:15], v[108:111], v[96:99], v[64:79]
    ds_read_b64_tr_b16 v[126:127], v129 offset:5760
    v_exp_f32 v21, v21
    v_exp_f32 v22, v22
    v_exp_f32 v23, v23
    v_exp_f32 v24, v24
    v_exp_f32 v25, v25
    v_exp_f32 v26, v26
    v_smfmac_f32_32x32x32_bf16 v[48:63], v[112:115], v[16:23], v133
    v_exp_f32 v27, v27
    v_exp_f32 v28, v28
    v_exp_f32 v29, v29
    v_exp_f32 v30, v30
    v_exp_f32 v31, v31
    v_exp_f32 v0, v0
    v_exp_f32 v1, v1
    v_smfmac_f32_32x32x32_bf16 v[48:63], v[116:119], v[24:31], v133
    s_waitcnt lgkmcnt(2)
    ds_read_b128 v[104:107], v128 offset:30720
    v_exp_f32 v2, v2
    v_exp_f32 v3, v3
    v_exp_f32 v4, v4
    v_mfma_f32_32x32x16_bf16 v[16:31], v[108:111], v[100:103], v[80:95]
    ds_read_b64_tr_b16 v[112:113], v129 offset:6144
    v_exp_f32 v5, v5
    v_exp_f32 v6, v6
    v_exp_f32 v7, v7
    v_exp_f32 v8, v8
    v_exp_f32 v9, v9
    v_exp_f32 v10, v10
    v_smfmac_f32_32x32x32_bf16 v[32:47], v[120:123], v[0:7], v133
    s_waitcnt lgkmcnt(2)
    ds_read_b64_tr_b16 v[114:115], v129 offset:6272
    v_exp_f32 v11, v11
    v_exp_f32 v12, v12
    v_exp_f32 v13, v13
    v_exp_f32 v14, v14
    v_exp_f32 v15, v15
    v_exp_f32 v16, v16
    v_exp_f32 v17, v17
    v_smfmac_f32_32x32x32_bf16 v[32:47], v[124:127], v[8:15], v133
    s_waitcnt lgkmcnt(2)
    ds_read_b64_tr_b16 v[116:117], v129 offset:6656
    v_exp_f32 v18, v18
    v_exp_f32 v19, v19
    v_exp_f32 v20, v20
    v_mfma_f32_32x32x16_bf16 v[0:15], v[104:107], v[96:99], v[64:79]
    ds_read_b64_tr_b16 v[118:119], v129 offset:6784
    v_exp_f32 v21, v21
    v_exp_f32 v22, v22
    v_exp_f32 v23, v23
    v_exp_f32 v24, v24
    v_exp_f32 v25, v25
    v_exp_f32 v26, v26
    v_smfmac_f32_32x32x32_bf16 v[48:63], v[120:123], v[16:23], v133
    v_exp_f32 v27, v27
    v_exp_f32 v28, v28
    v_exp_f32 v29, v29
    v_exp_f32 v30, v30
    v_exp_f32 v31, v31
    v_exp_f32 v0, v0
    v_exp_f32 v1, v1
    v_smfmac_f32_32x32x32_bf16 v[48:63], v[124:127], v[24:31], v133
    s_waitcnt lgkmcnt(2)
    ds_read_b128 v[108:111], v128 offset:31744
    v_exp_f32 v2, v2
    v_exp_f32 v3, v3
    v_exp_f32 v4, v4
    v_mfma_f32_32x32x16_bf16 v[16:31], v[104:107], v[100:103], v[80:95]
    ds_read_b64_tr_b16 v[120:121], v129 offset:7168
    v_exp_f32 v5, v5
    v_exp_f32 v6, v6
    v_exp_f32 v7, v7
    v_exp_f32 v8, v8
    v_exp_f32 v9, v9
    v_exp_f32 v10, v10
    v_smfmac_f32_32x32x32_bf16 v[32:47], v[112:115], v[0:7], v133
    s_waitcnt lgkmcnt(2)
    ds_read_b64_tr_b16 v[122:123], v129 offset:7296
    v_exp_f32 v11, v11
    v_exp_f32 v12, v12
    v_exp_f32 v13, v13
    v_exp_f32 v14, v14
    v_exp_f32 v15, v15
    v_exp_f32 v16, v16
    v_exp_f32 v17, v17
    v_smfmac_f32_32x32x32_bf16 v[32:47], v[116:119], v[8:15], v133
    s_waitcnt lgkmcnt(2)
    ds_read_b64_tr_b16 v[124:125], v129 offset:7680
    v_exp_f32 v18, v18
    v_exp_f32 v19, v19
    v_exp_f32 v20, v20
    v_mfma_f32_32x32x16_bf16 v[0:15], v[108:111], v[96:99], v[64:79]
    ds_read_b64_tr_b16 v[126:127], v129 offset:7808
    v_exp_f32 v21, v21
    v_exp_f32 v22, v22
    v_exp_f32 v23, v23
    v_exp_f32 v24, v24
    v_exp_f32 v25, v25
    v_exp_f32 v26, v26
    v_smfmac_f32_32x32x32_bf16 v[48:63], v[112:115], v[16:23], v133
    s_cbranch_scc0 L_skip61
    s_barrier
L_skip61:
    v_add_u32 v129, v130, v129
    v_exp_f32 v27, v27
    v_exp_f32 v28, v28
    v_exp_f32 v29, v29
    v_exp_f32 v30, v30
    v_exp_f32 v31, v31
    v_exp_f32 v0, v0
    v_exp_f32 v1, v1
    v_smfmac_f32_32x32x32_bf16 v[48:63], v[116:119], v[24:31], v133
    s_waitcnt lgkmcnt(2)
    ds_read_b128 v[104:107], v128 offset:32768
    v_exp_f32 v2, v2
    v_exp_f32 v3, v3
    v_exp_f32 v4, v4
    v_mfma_f32_32x32x16_bf16 v[16:31], v[108:111], v[100:103], v[80:95]
    ds_read_b64_tr_b16 v[112:113], v129 offset:0
    v_exp_f32 v5, v5
    v_exp_f32 v6, v6
    v_exp_f32 v7, v7
    v_exp_f32 v8, v8
    v_exp_f32 v9, v9
    v_exp_f32 v10, v10
    v_smfmac_f32_32x32x32_bf16 v[32:47], v[120:123], v[0:7], v133
    s_waitcnt lgkmcnt(2)
    ds_read_b64_tr_b16 v[114:115], v129 offset:128
    v_exp_f32 v11, v11
    v_exp_f32 v12, v12
    v_exp_f32 v13, v13
    v_exp_f32 v14, v14
    v_exp_f32 v15, v15
    v_exp_f32 v16, v16
    v_exp_f32 v17, v17
    v_smfmac_f32_32x32x32_bf16 v[32:47], v[124:127], v[8:15], v133
    s_waitcnt lgkmcnt(2)
    ds_read_b64_tr_b16 v[116:117], v129 offset:512
    v_exp_f32 v18, v18
    v_exp_f32 v19, v19
    v_exp_f32 v20, v20
    v_mfma_f32_32x32x16_bf16 v[0:15], v[104:107], v[96:99], v[64:79]
    ds_read_b64_tr_b16 v[118:119], v129 offset:640
    v_exp_f32 v21, v21
    v_exp_f32 v22, v22
    v_exp_f32 v23, v23
    v_exp_f32 v24, v24
    v_exp_f32 v25, v25
    v_exp_f32 v26, v26
    v_smfmac_f32_32x32x32_bf16 v[48:63], v[120:123], v[16:23], v133
    v_exp_f32 v27, v27
    v_exp_f32 v28, v28
    v_exp_f32 v29, v29
    v_exp_f32 v30, v30
    v_exp_f32 v31, v31
    v_exp_f32 v0, v0
    v_exp_f32 v1, v1
    v_smfmac_f32_32x32x32_bf16 v[48:63], v[124:127], v[24:31], v133
    s_waitcnt lgkmcnt(2)
    ds_read_b128 v[108:111], v128 offset:33792
    v_exp_f32 v2, v2
    v_exp_f32 v3, v3
    v_exp_f32 v4, v4
    v_mfma_f32_32x32x16_bf16 v[16:31], v[104:107], v[100:103], v[80:95]
    ds_read_b64_tr_b16 v[120:121], v129 offset:1024
    v_exp_f32 v5, v5
    v_exp_f32 v6, v6
    v_exp_f32 v7, v7
    v_exp_f32 v8, v8
    v_exp_f32 v9, v9
    v_exp_f32 v10, v10
    v_smfmac_f32_32x32x32_bf16 v[32:47], v[112:115], v[0:7], v133
    s_waitcnt lgkmcnt(2)
    ds_read_b64_tr_b16 v[122:123], v129 offset:1152
    v_exp_f32 v11, v11
    v_exp_f32 v12, v12
    v_exp_f32 v13, v13
    v_exp_f32 v14, v14
    v_exp_f32 v15, v15
    v_exp_f32 v16, v16
    v_exp_f32 v17, v17
    v_smfmac_f32_32x32x32_bf16 v[32:47], v[116:119], v[8:15], v133
    s_waitcnt lgkmcnt(2)
    ds_read_b64_tr_b16 v[124:125], v129 offset:1536
    v_exp_f32 v18, v18
    v_exp_f32 v19, v19
    v_exp_f32 v20, v20
    v_mfma_f32_32x32x16_bf16 v[0:15], v[108:111], v[96:99], v[64:79]
    ds_read_b64_tr_b16 v[126:127], v129 offset:1664
    v_exp_f32 v21, v21
    v_exp_f32 v22, v22
    v_exp_f32 v23, v23
    v_exp_f32 v24, v24
    v_exp_f32 v25, v25
    v_exp_f32 v26, v26
    v_smfmac_f32_32x32x32_bf16 v[48:63], v[112:115], v[16:23], v133
    v_exp_f32 v27, v27
    v_exp_f32 v28, v28
    v_exp_f32 v29, v29
    v_exp_f32 v30, v30
    v_exp_f32 v31, v31
    v_exp_f32 v0, v0
    v_exp_f32 v1, v1
    v_smfmac_f32_32x32x32_bf16 v[48:63], v[116:119], v[24:31], v133
    s_waitcnt lgkmcnt(2)
    ds_read_b128 v[104:107], v128 offset:34816
    v_exp_f32 v2, v2
    v_exp_f32 v3, v3
    v_exp_f32 v4, v4
    v_mfma_f32_32x32x16_bf16 v[16:31], v[108:111], v[100:103], v[80:95]
    ds_read_b64_tr_b16 v[112:113], v129 offset:2048
    v_exp_f32 v5, v5
    v_exp_f32 v6, v6
    v_exp_f32 v7, v7
    v_exp_f32 v8, v8
    v_exp_f32 v9, v9
    v_exp_f32 v10, v10
    v_smfmac_f32_32x32x32_bf16 v[32:47], v[120:123], v[0:7], v133
    s_waitcnt lgkmcnt(2)
    ds_read_b64_tr_b16 v[114:115], v129 offset:2176
    v_exp_f32 v11, v11
    v_exp_f32 v12, v12
    v_exp_f32 v13, v13
    v_exp_f32 v14, v14
    v_exp_f32 v15, v15
    v_exp_f32 v16, v16
    v_exp_f32 v17, v17
    v_smfmac_f32_32x32x32_bf16 v[32:47], v[124:127], v[8:15], v133
    s_waitcnt lgkmcnt(2)
    ds_read_b64_tr_b16 v[116:117], v129 offset:2560
    v_exp_f32 v18, v18
    v_exp_f32 v19, v19
    v_exp_f32 v20, v20
    v_mfma_f32_32x32x16_bf16 v[0:15], v[104:107], v[96:99], v[64:79]
    ds_read_b64_tr_b16 v[118:119], v129 offset:2688
    v_exp_f32 v21, v21
    v_exp_f32 v22, v22
    v_exp_f32 v23, v23
    v_exp_f32 v24, v24
    v_exp_f32 v25, v25
    v_exp_f32 v26, v26
    v_smfmac_f32_32x32x32_bf16 v[48:63], v[120:123], v[16:23], v133
    v_exp_f32 v27, v27
    v_exp_f32 v28, v28
    v_exp_f32 v29, v29
    v_exp_f32 v30, v30
    v_exp_f32 v31, v31
    v_exp_f32 v0, v0
    v_exp_f32 v1, v1
    v_smfmac_f32_32x32x32_bf16 v[48:63], v[124:127], v[24:31], v133
    s_waitcnt lgkmcnt(2)
    ds_read_b128 v[108:111], v128 offset:35840
    v_exp_f32 v2, v2
    v_exp_f32 v3, v3
    v_exp_f32 v4, v4
    v_mfma_f32_32x32x16_bf16 v[16:31], v[104:107], v[100:103], v[80:95]
    ds_read_b64_tr_b16 v[120:121], v129 offset:3072
    v_exp_f32 v5, v5
    v_exp_f32 v6, v6
    v_exp_f32 v7, v7
    v_exp_f32 v8, v8
    v_exp_f32 v9, v9
    v_exp_f32 v10, v10
    v_smfmac_f32_32x32x32_bf16 v[32:47], v[112:115], v[0:7], v133
    s_waitcnt lgkmcnt(2)
    ds_read_b64_tr_b16 v[122:123], v129 offset:3200
    v_exp_f32 v11, v11
    v_exp_f32 v12, v12
    v_exp_f32 v13, v13
    v_exp_f32 v14, v14
    v_exp_f32 v15, v15
    v_exp_f32 v16, v16
    v_exp_f32 v17, v17
    v_smfmac_f32_32x32x32_bf16 v[32:47], v[116:119], v[8:15], v133
    s_waitcnt lgkmcnt(2)
    ds_read_b64_tr_b16 v[124:125], v129 offset:3584
    v_exp_f32 v18, v18
    v_exp_f32 v19, v19
    v_exp_f32 v20, v20
    v_mfma_f32_32x32x16_bf16 v[0:15], v[108:111], v[96:99], v[64:79]
    ds_read_b64_tr_b16 v[126:127], v129 offset:3712
    v_exp_f32 v21, v21
    v_exp_f32 v22, v22
    v_exp_f32 v23, v23
    v_exp_f32 v24, v24
    v_exp_f32 v25, v25
    v_exp_f32 v26, v26
    v_smfmac_f32_32x32x32_bf16 v[48:63], v[112:115], v[16:23], v133
    v_exp_f32 v27, v27
    v_exp_f32 v28, v28
    v_exp_f32 v29, v29
    v_exp_f32 v30, v30
    v_exp_f32 v31, v31
    v_exp_f32 v0, v0
    v_exp_f32 v1, v1
    v_smfmac_f32_32x32x32_bf16 v[48:63], v[116:119], v[24:31], v133
    s_waitcnt lgkmcnt(2)
    ds_read_b128 v[104:107], v128 offset:36864
    v_exp_f32 v2, v2
    v_exp_f32 v3, v3
    v_exp_f32 v4, v4
    v_mfma_f32_32x32x16_bf16 v[16:31], v[108:111], v[100:103], v[80:95]
    ds_read_b64_tr_b16 v[112:113], v129 offset:4096
    v_exp_f32 v5, v5
    v_exp_f32 v6, v6
    v_exp_f32 v7, v7
    v_exp_f32 v8, v8
    v_exp_f32 v9, v9
    v_exp_f32 v10, v10
    v_smfmac_f32_32x32x32_bf16 v[32:47], v[120:123], v[0:7], v133
    s_waitcnt lgkmcnt(2)
    ds_read_b64_tr_b16 v[114:115], v129 offset:4224
    v_exp_f32 v11, v11
    v_exp_f32 v12, v12
    v_exp_f32 v13, v13
    v_exp_f32 v14, v14
    v_exp_f32 v15, v15
    v_exp_f32 v16, v16
    v_exp_f32 v17, v17
    v_smfmac_f32_32x32x32_bf16 v[32:47], v[124:127], v[8:15], v133
    s_waitcnt lgkmcnt(2)
    ds_read_b64_tr_b16 v[116:117], v129 offset:4608
    v_exp_f32 v18, v18
    v_exp_f32 v19, v19
    v_exp_f32 v20, v20
    v_mfma_f32_32x32x16_bf16 v[0:15], v[104:107], v[96:99], v[64:79]
    ds_read_b64_tr_b16 v[118:119], v129 offset:4736
    v_exp_f32 v21, v21
    v_exp_f32 v22, v22
    v_exp_f32 v23, v23
    v_exp_f32 v24, v24
    v_exp_f32 v25, v25
    v_exp_f32 v26, v26
    v_smfmac_f32_32x32x32_bf16 v[48:63], v[120:123], v[16:23], v133
    v_exp_f32 v27, v27
    v_exp_f32 v28, v28
    v_exp_f32 v29, v29
    v_exp_f32 v30, v30
    v_exp_f32 v31, v31
    v_exp_f32 v0, v0
    v_exp_f32 v1, v1
    v_smfmac_f32_32x32x32_bf16 v[48:63], v[124:127], v[24:31], v133
    s_waitcnt lgkmcnt(2)
    ds_read_b128 v[108:111], v128 offset:37888
    v_exp_f32 v2, v2
    v_exp_f32 v3, v3
    v_exp_f32 v4, v4
    v_mfma_f32_32x32x16_bf16 v[16:31], v[104:107], v[100:103], v[80:95]
    ds_read_b64_tr_b16 v[120:121], v129 offset:5120
    v_exp_f32 v5, v5
    v_exp_f32 v6, v6
    v_exp_f32 v7, v7
    v_exp_f32 v8, v8
    v_exp_f32 v9, v9
    v_exp_f32 v10, v10
    v_smfmac_f32_32x32x32_bf16 v[32:47], v[112:115], v[0:7], v133
    s_waitcnt lgkmcnt(2)
    ds_read_b64_tr_b16 v[122:123], v129 offset:5248
    v_exp_f32 v11, v11
    v_exp_f32 v12, v12
    v_exp_f32 v13, v13
    v_exp_f32 v14, v14
    v_exp_f32 v15, v15
    v_exp_f32 v16, v16
    v_exp_f32 v17, v17
    v_smfmac_f32_32x32x32_bf16 v[32:47], v[116:119], v[8:15], v133
    s_waitcnt lgkmcnt(2)
    ds_read_b64_tr_b16 v[124:125], v129 offset:5632
    v_exp_f32 v18, v18
    v_exp_f32 v19, v19
    v_exp_f32 v20, v20
    v_mfma_f32_32x32x16_bf16 v[0:15], v[108:111], v[96:99], v[64:79]
    ds_read_b64_tr_b16 v[126:127], v129 offset:5760
    v_exp_f32 v21, v21
    v_exp_f32 v22, v22
    v_exp_f32 v23, v23
    v_exp_f32 v24, v24
    v_exp_f32 v25, v25
    v_exp_f32 v26, v26
    v_smfmac_f32_32x32x32_bf16 v[48:63], v[112:115], v[16:23], v133
    v_exp_f32 v27, v27
    v_exp_f32 v28, v28
    v_exp_f32 v29, v29
    v_exp_f32 v30, v30
    v_exp_f32 v31, v31
    v_exp_f32 v0, v0
    v_exp_f32 v1, v1
    v_smfmac_f32_32x32x32_bf16 v[48:63], v[116:119], v[24:31], v133
    s_waitcnt lgkmcnt(2)
    ds_read_b128 v[104:107], v128 offset:38912
    v_exp_f32 v2, v2
    v_exp_f32 v3, v3
    v_exp_f32 v4, v4
    v_mfma_f32_32x32x16_bf16 v[16:31], v[108:111], v[100:103], v[80:95]
    ds_read_b64_tr_b16 v[112:113], v129 offset:6144
    v_exp_f32 v5, v5
    v_exp_f32 v6, v6
    v_exp_f32 v7, v7
    v_exp_f32 v8, v8
    v_exp_f32 v9, v9
    v_exp_f32 v10, v10
    v_smfmac_f32_32x32x32_bf16 v[32:47], v[120:123], v[0:7], v133
    s_waitcnt lgkmcnt(2)
    ds_read_b64_tr_b16 v[114:115], v129 offset:6272
    v_exp_f32 v11, v11
    v_exp_f32 v12, v12
    v_exp_f32 v13, v13
    v_exp_f32 v14, v14
    v_exp_f32 v15, v15
    v_exp_f32 v16, v16
    v_exp_f32 v17, v17
    v_smfmac_f32_32x32x32_bf16 v[32:47], v[124:127], v[8:15], v133
    s_waitcnt lgkmcnt(2)
    ds_read_b64_tr_b16 v[116:117], v129 offset:6656
    v_exp_f32 v18, v18
    v_exp_f32 v19, v19
    v_exp_f32 v20, v20
    v_mfma_f32_32x32x16_bf16 v[0:15], v[104:107], v[96:99], v[64:79]
    ds_read_b64_tr_b16 v[118:119], v129 offset:6784
    v_exp_f32 v21, v21
    v_exp_f32 v22, v22
    v_exp_f32 v23, v23
    v_exp_f32 v24, v24
    v_exp_f32 v25, v25
    v_exp_f32 v26, v26
    v_smfmac_f32_32x32x32_bf16 v[48:63], v[120:123], v[16:23], v133
    v_exp_f32 v27, v27
    v_exp_f32 v28, v28
    v_exp_f32 v29, v29
    v_exp_f32 v30, v30
    v_exp_f32 v31, v31
    v_exp_f32 v0, v0
    v_exp_f32 v1, v1
    v_smfmac_f32_32x32x32_bf16 v[48:63], v[124:127], v[24:31], v133
    s_waitcnt lgkmcnt(2)
    ds_read_b128 v[108:111], v128 offset:39936
    v_exp_f32 v2, v2
    v_exp_f32 v3, v3
    v_exp_f32 v4, v4
    v_mfma_f32_32x32x16_bf16 v[16:31], v[104:107], v[100:103], v[80:95]
    ds_read_b64_tr_b16 v[120:121], v129 offset:7168
    v_exp_f32 v5, v5
    v_exp_f32 v6, v6
    v_exp_f32 v7, v7
    v_exp_f32 v8, v8
    v_exp_f32 v9, v9
    v_exp_f32 v10, v10
    v_smfmac_f32_32x32x32_bf16 v[32:47], v[112:115], v[0:7], v133
    s_waitcnt lgkmcnt(2)
    ds_read_b64_tr_b16 v[122:123], v129 offset:7296
    v_exp_f32 v11, v11
    v_exp_f32 v12, v12
    v_exp_f32 v13, v13
    v_exp_f32 v14, v14
    v_exp_f32 v15, v15
    v_exp_f32 v16, v16
    v_exp_f32 v17, v17
    v_smfmac_f32_32x32x32_bf16 v[32:47], v[116:119], v[8:15], v133
    s_waitcnt lgkmcnt(2)
    ds_read_b64_tr_b16 v[124:125], v129 offset:7680
    v_exp_f32 v18, v18
    v_exp_f32 v19, v19
    v_exp_f32 v20, v20
    v_mfma_f32_32x32x16_bf16 v[0:15], v[108:111], v[96:99], v[64:79]
    ds_read_b64_tr_b16 v[126:127], v129 offset:7808
    v_exp_f32 v21, v21
    v_exp_f32 v22, v22
    v_exp_f32 v23, v23
    v_exp_f32 v24, v24
    v_exp_f32 v25, v25
    v_exp_f32 v26, v26
    v_smfmac_f32_32x32x32_bf16 v[48:63], v[112:115], v[16:23], v133
    v_add_u32 v129, v130, v129
    v_exp_f32 v27, v27
    v_exp_f32 v28, v28
    v_exp_f32 v29, v29
    v_exp_f32 v30, v30
    v_exp_f32 v31, v31
    v_exp_f32 v0, v0
    v_exp_f32 v1, v1
    v_smfmac_f32_32x32x32_bf16 v[48:63], v[116:119], v[24:31], v133
    s_waitcnt lgkmcnt(2)
    ds_read_b128 v[104:107], v128 offset:40960
    v_exp_f32 v2, v2
    v_exp_f32 v3, v3
    v_exp_f32 v4, v4
    v_mfma_f32_32x32x16_bf16 v[16:31], v[108:111], v[100:103], v[80:95]
    ds_read_b64_tr_b16 v[112:113], v129 offset:0
    v_exp_f32 v5, v5
    v_exp_f32 v6, v6
    v_exp_f32 v7, v7
    v_exp_f32 v8, v8
    v_exp_f32 v9, v9
    v_exp_f32 v10, v10
    v_smfmac_f32_32x32x32_bf16 v[32:47], v[120:123], v[0:7], v133
    s_waitcnt lgkmcnt(2)
    ds_read_b64_tr_b16 v[114:115], v129 offset:128
    v_exp_f32 v11, v11
    v_exp_f32 v12, v12
    v_exp_f32 v13, v13
    v_exp_f32 v14, v14
    v_exp_f32 v15, v15
    v_exp_f32 v16, v16
    v_exp_f32 v17, v17
    v_smfmac_f32_32x32x32_bf16 v[32:47], v[124:127], v[8:15], v133
    s_waitcnt lgkmcnt(2)
    ds_read_b64_tr_b16 v[116:117], v129 offset:512
    v_exp_f32 v18, v18
    v_exp_f32 v19, v19
    v_exp_f32 v20, v20
    v_mfma_f32_32x32x16_bf16 v[0:15], v[104:107], v[96:99], v[64:79]
    ds_read_b64_tr_b16 v[118:119], v129 offset:640
    v_exp_f32 v21, v21
    v_exp_f32 v22, v22
    v_exp_f32 v23, v23
    v_exp_f32 v24, v24
    v_exp_f32 v25, v25
    v_exp_f32 v26, v26
    v_smfmac_f32_32x32x32_bf16 v[48:63], v[120:123], v[16:23], v133
    v_exp_f32 v27, v27
    v_exp_f32 v28, v28
    v_exp_f32 v29, v29
    v_exp_f32 v30, v30
    v_exp_f32 v31, v31
    v_exp_f32 v0, v0
    v_exp_f32 v1, v1
    v_smfmac_f32_32x32x32_bf16 v[48:63], v[124:127], v[24:31], v133
    s_waitcnt lgkmcnt(2)
    ds_read_b128 v[108:111], v128 offset:41984
    v_exp_f32 v2, v2
    v_exp_f32 v3, v3
    v_exp_f32 v4, v4
    v_mfma_f32_32x32x16_bf16 v[16:31], v[104:107], v[100:103], v[80:95]
    ds_read_b64_tr_b16 v[120:121], v129 offset:1024
    v_exp_f32 v5, v5
    v_exp_f32 v6, v6
    v_exp_f32 v7, v7
    v_exp_f32 v8, v8
    v_exp_f32 v9, v9
    v_exp_f32 v10, v10
    v_smfmac_f32_32x32x32_bf16 v[32:47], v[112:115], v[0:7], v133
    s_waitcnt lgkmcnt(2)
    ds_read_b64_tr_b16 v[122:123], v129 offset:1152
    v_exp_f32 v11, v11
    v_exp_f32 v12, v12
    v_exp_f32 v13, v13
    v_exp_f32 v14, v14
    v_exp_f32 v15, v15
    v_exp_f32 v16, v16
    v_exp_f32 v17, v17
    v_smfmac_f32_32x32x32_bf16 v[32:47], v[116:119], v[8:15], v133
    s_waitcnt lgkmcnt(2)
    ds_read_b64_tr_b16 v[124:125], v129 offset:1536
    v_exp_f32 v18, v18
    v_exp_f32 v19, v19
    v_exp_f32 v20, v20
    v_mfma_f32_32x32x16_bf16 v[0:15], v[108:111], v[96:99], v[64:79]
    ds_read_b64_tr_b16 v[126:127], v129 offset:1664
    v_exp_f32 v21, v21
    v_exp_f32 v22, v22
    v_exp_f32 v23, v23
    v_exp_f32 v24, v24
    v_exp_f32 v25, v25
    v_exp_f32 v26, v26
    v_smfmac_f32_32x32x32_bf16 v[48:63], v[112:115], v[16:23], v133
    v_exp_f32 v27, v27
    v_exp_f32 v28, v28
    v_exp_f32 v29, v29
    v_exp_f32 v30, v30
    v_exp_f32 v31, v31
    v_exp_f32 v0, v0
    v_exp_f32 v1, v1
    v_smfmac_f32_32x32x32_bf16 v[48:63], v[116:119], v[24:31], v133
    s_waitcnt lgkmcnt(2)
    ds_read_b128 v[104:107], v128 offset:43008
    v_exp_f32 v2, v2
    v_exp_f32 v3, v3
    v_exp_f32 v4, v4
    v_mfma_f32_32x32x16_bf16 v[16:31], v[108:111], v[100:103], v[80:95]
    ds_read_b64_tr_b16 v[112:113], v129 offset:2048
    v_exp_f32 v5, v5
    v_exp_f32 v6, v6
    v_exp_f32 v7, v7
    v_exp_f32 v8, v8
    v_exp_f32 v9, v9
    v_exp_f32 v10, v10
    v_smfmac_f32_32x32x32_bf16 v[32:47], v[120:123], v[0:7], v133
    s_waitcnt lgkmcnt(2)
    ds_read_b64_tr_b16 v[114:115], v129 offset:2176
    v_exp_f32 v11, v11
    v_exp_f32 v12, v12
    v_exp_f32 v13, v13
    v_exp_f32 v14, v14
    v_exp_f32 v15, v15
    v_exp_f32 v16, v16
    v_exp_f32 v17, v17
    v_smfmac_f32_32x32x32_bf16 v[32:47], v[124:127], v[8:15], v133
    s_waitcnt lgkmcnt(2)
    ds_read_b64_tr_b16 v[116:117], v129 offset:2560
    v_exp_f32 v18, v18
    v_exp_f32 v19, v19
    v_exp_f32 v20, v20
    v_mfma_f32_32x32x16_bf16 v[0:15], v[104:107], v[96:99], v[64:79]
    ds_read_b64_tr_b16 v[118:119], v129 offset:2688
    v_exp_f32 v21, v21
    v_exp_f32 v22, v22
    v_exp_f32 v23, v23
    v_exp_f32 v24, v24
    v_exp_f32 v25, v25
    v_exp_f32 v26, v26
    v_smfmac_f32_32x32x32_bf16 v[48:63], v[120:123], v[16:23], v133
    v_exp_f32 v27, v27
    v_exp_f32 v28, v28
    v_exp_f32 v29, v29
    v_exp_f32 v30, v30
    v_exp_f32 v31, v31
    v_exp_f32 v0, v0
    v_exp_f32 v1, v1
    v_smfmac_f32_32x32x32_bf16 v[48:63], v[124:127], v[24:31], v133
    s_waitcnt lgkmcnt(2)
    ds_read_b128 v[108:111], v128 offset:44032
    v_exp_f32 v2, v2
    v_exp_f32 v3, v3
    v_exp_f32 v4, v4
    v_mfma_f32_32x32x16_bf16 v[16:31], v[104:107], v[100:103], v[80:95]
    ds_read_b64_tr_b16 v[120:121], v129 offset:3072
    v_exp_f32 v5, v5
    v_exp_f32 v6, v6
    v_exp_f32 v7, v7
    v_exp_f32 v8, v8
    v_exp_f32 v9, v9
    v_exp_f32 v10, v10
    v_smfmac_f32_32x32x32_bf16 v[32:47], v[112:115], v[0:7], v133
    s_waitcnt lgkmcnt(2)
    ds_read_b64_tr_b16 v[122:123], v129 offset:3200
    v_exp_f32 v11, v11
    v_exp_f32 v12, v12
    v_exp_f32 v13, v13
    v_exp_f32 v14, v14
    v_exp_f32 v15, v15
    v_exp_f32 v16, v16
    v_exp_f32 v17, v17
    v_smfmac_f32_32x32x32_bf16 v[32:47], v[116:119], v[8:15], v133
    s_waitcnt lgkmcnt(2)
    ds_read_b64_tr_b16 v[124:125], v129 offset:3584
    v_exp_f32 v18, v18
    v_exp_f32 v19, v19
    v_exp_f32 v20, v20
    v_mfma_f32_32x32x16_bf16 v[0:15], v[108:111], v[96:99], v[64:79]
    ds_read_b64_tr_b16 v[126:127], v129 offset:3712
    v_exp_f32 v21, v21
    v_exp_f32 v22, v22
    v_exp_f32 v23, v23
    v_exp_f32 v24, v24
    v_exp_f32 v25, v25
    v_exp_f32 v26, v26
    v_smfmac_f32_32x32x32_bf16 v[48:63], v[112:115], v[16:23], v133
    v_exp_f32 v27, v27
    v_exp_f32 v28, v28
    v_exp_f32 v29, v29
    v_exp_f32 v30, v30
    v_exp_f32 v31, v31
    v_exp_f32 v0, v0
    v_exp_f32 v1, v1
    v_smfmac_f32_32x32x32_bf16 v[48:63], v[116:119], v[24:31], v133
    s_waitcnt lgkmcnt(2)
    ds_read_b128 v[104:107], v128 offset:45056
    v_exp_f32 v2, v2
    v_exp_f32 v3, v3
    v_exp_f32 v4, v4
    v_mfma_f32_32x32x16_bf16 v[16:31], v[108:111], v[100:103], v[80:95]
    ds_read_b64_tr_b16 v[112:113], v129 offset:4096
    v_exp_f32 v5, v5
    v_exp_f32 v6, v6
    v_exp_f32 v7, v7
    v_exp_f32 v8, v8
    v_exp_f32 v9, v9
    v_exp_f32 v10, v10
    v_smfmac_f32_32x32x32_bf16 v[32:47], v[120:123], v[0:7], v133
    s_waitcnt lgkmcnt(2)
    ds_read_b64_tr_b16 v[114:115], v129 offset:4224
    v_exp_f32 v11, v11
    v_exp_f32 v12, v12
    v_exp_f32 v13, v13
    v_exp_f32 v14, v14
    v_exp_f32 v15, v15
    v_exp_f32 v16, v16
    v_exp_f32 v17, v17
    v_smfmac_f32_32x32x32_bf16 v[32:47], v[124:127], v[8:15], v133
    s_waitcnt lgkmcnt(2)
    ds_read_b64_tr_b16 v[116:117], v129 offset:4608
    v_exp_f32 v18, v18
    v_exp_f32 v19, v19
    v_exp_f32 v20, v20
    v_mfma_f32_32x32x16_bf16 v[0:15], v[104:107], v[96:99], v[64:79]
    ds_read_b64_tr_b16 v[118:119], v129 offset:4736
    v_exp_f32 v21, v21
    v_exp_f32 v22, v22
    v_exp_f32 v23, v23
    v_exp_f32 v24, v24
    v_exp_f32 v25, v25
    v_exp_f32 v26, v26
    v_smfmac_f32_32x32x32_bf16 v[48:63], v[120:123], v[16:23], v133
    v_exp_f32 v27, v27
    v_exp_f32 v28, v28
    v_exp_f32 v29, v29
    v_exp_f32 v30, v30
    v_exp_f32 v31, v31
    v_exp_f32 v0, v0
    v_exp_f32 v1, v1
    v_smfmac_f32_32x32x32_bf16 v[48:63], v[124:127], v[24:31], v133
    s_waitcnt lgkmcnt(2)
    ds_read_b128 v[108:111], v128 offset:46080
    v_exp_f32 v2, v2
    v_exp_f32 v3, v3
    v_exp_f32 v4, v4
    v_mfma_f32_32x32x16_bf16 v[16:31], v[104:107], v[100:103], v[80:95]
    ds_read_b64_tr_b16 v[120:121], v129 offset:5120
    v_exp_f32 v5, v5
    v_exp_f32 v6, v6
    v_exp_f32 v7, v7
    v_exp_f32 v8, v8
    v_exp_f32 v9, v9
    v_exp_f32 v10, v10
    v_smfmac_f32_32x32x32_bf16 v[32:47], v[112:115], v[0:7], v133
    s_waitcnt lgkmcnt(2)
    ds_read_b64_tr_b16 v[122:123], v129 offset:5248
    v_exp_f32 v11, v11
    v_exp_f32 v12, v12
    v_exp_f32 v13, v13
    v_exp_f32 v14, v14
    v_exp_f32 v15, v15
    v_exp_f32 v16, v16
    v_exp_f32 v17, v17
    v_smfmac_f32_32x32x32_bf16 v[32:47], v[116:119], v[8:15], v133
    s_waitcnt lgkmcnt(2)
    ds_read_b64_tr_b16 v[124:125], v129 offset:5632
    v_exp_f32 v18, v18
    v_exp_f32 v19, v19
    v_exp_f32 v20, v20
    v_mfma_f32_32x32x16_bf16 v[0:15], v[108:111], v[96:99], v[64:79]
    ds_read_b64_tr_b16 v[126:127], v129 offset:5760
    v_exp_f32 v21, v21
    v_exp_f32 v22, v22
    v_exp_f32 v23, v23
    v_exp_f32 v24, v24
    v_exp_f32 v25, v25
    v_exp_f32 v26, v26
    v_smfmac_f32_32x32x32_bf16 v[48:63], v[112:115], v[16:23], v133
    v_exp_f32 v27, v27
    v_exp_f32 v28, v28
    v_exp_f32 v29, v29
    v_exp_f32 v30, v30
    v_exp_f32 v31, v31
    v_exp_f32 v0, v0
    v_exp_f32 v1, v1
    v_smfmac_f32_32x32x32_bf16 v[48:63], v[116:119], v[24:31], v133
    s_waitcnt lgkmcnt(2)
    ds_read_b128 v[104:107], v128 offset:47104
    v_exp_f32 v2, v2
    v_exp_f32 v3, v3
    v_exp_f32 v4, v4
    v_mfma_f32_32x32x16_bf16 v[16:31], v[108:111], v[100:103], v[80:95]
    ds_read_b64_tr_b16 v[112:113], v129 offset:6144
    v_exp_f32 v5, v5
    v_exp_f32 v6, v6
    v_exp_f32 v7, v7
    v_exp_f32 v8, v8
    v_exp_f32 v9, v9
    v_exp_f32 v10, v10
    v_smfmac_f32_32x32x32_bf16 v[32:47], v[120:123], v[0:7], v133
    s_waitcnt lgkmcnt(2)
    ds_read_b64_tr_b16 v[114:115], v129 offset:6272
    v_exp_f32 v11, v11
    v_exp_f32 v12, v12
    v_exp_f32 v13, v13
    v_exp_f32 v14, v14
    v_exp_f32 v15, v15
    v_exp_f32 v16, v16
    v_exp_f32 v17, v17
    v_smfmac_f32_32x32x32_bf16 v[32:47], v[124:127], v[8:15], v133
    s_waitcnt lgkmcnt(2)
    ds_read_b64_tr_b16 v[116:117], v129 offset:6656
    v_exp_f32 v18, v18
    v_exp_f32 v19, v19
    v_exp_f32 v20, v20
    v_mfma_f32_32x32x16_bf16 v[0:15], v[104:107], v[96:99], v[64:79]
    ds_read_b64_tr_b16 v[118:119], v129 offset:6784
    v_exp_f32 v21, v21
    v_exp_f32 v22, v22
    v_exp_f32 v23, v23
    v_exp_f32 v24, v24
    v_exp_f32 v25, v25
    v_exp_f32 v26, v26
    v_smfmac_f32_32x32x32_bf16 v[48:63], v[120:123], v[16:23], v133
    v_exp_f32 v27, v27
    v_exp_f32 v28, v28
    v_exp_f32 v29, v29
    v_exp_f32 v30, v30
    v_exp_f32 v31, v31
    v_exp_f32 v0, v0
    v_exp_f32 v1, v1
    v_smfmac_f32_32x32x32_bf16 v[48:63], v[124:127], v[24:31], v133
    s_waitcnt lgkmcnt(2)
    ds_read_b128 v[108:111], v128 offset:48128
    v_exp_f32 v2, v2
    v_exp_f32 v3, v3
    v_exp_f32 v4, v4
    v_mfma_f32_32x32x16_bf16 v[16:31], v[104:107], v[100:103], v[80:95]
    ds_read_b64_tr_b16 v[120:121], v129 offset:7168
    v_exp_f32 v5, v5
    v_exp_f32 v6, v6
    v_exp_f32 v7, v7
    v_exp_f32 v8, v8
    v_exp_f32 v9, v9
    v_exp_f32 v10, v10
    v_smfmac_f32_32x32x32_bf16 v[32:47], v[112:115], v[0:7], v133
    s_waitcnt lgkmcnt(2)
    ds_read_b64_tr_b16 v[122:123], v129 offset:7296
    v_exp_f32 v11, v11
    v_exp_f32 v12, v12
    v_exp_f32 v13, v13
    v_exp_f32 v14, v14
    v_exp_f32 v15, v15
    v_exp_f32 v16, v16
    v_exp_f32 v17, v17
    v_smfmac_f32_32x32x32_bf16 v[32:47], v[116:119], v[8:15], v133
    s_waitcnt lgkmcnt(2)
    ds_read_b64_tr_b16 v[124:125], v129 offset:7680
    v_exp_f32 v18, v18
    v_exp_f32 v19, v19
    v_exp_f32 v20, v20
    v_mfma_f32_32x32x16_bf16 v[0:15], v[108:111], v[96:99], v[64:79]
    ds_read_b64_tr_b16 v[126:127], v129 offset:7808
    v_exp_f32 v21, v21
    v_exp_f32 v22, v22
    v_exp_f32 v23, v23
    v_exp_f32 v24, v24
    v_exp_f32 v25, v25
    v_exp_f32 v26, v26
    v_smfmac_f32_32x32x32_bf16 v[48:63], v[112:115], v[16:23], v133
    v_add_u32 v129, v130, v129
    v_exp_f32 v27, v27
    v_exp_f32 v28, v28
    v_exp_f32 v29, v29
    v_exp_f32 v30, v30
    v_exp_f32 v31, v31
    v_exp_f32 v0, v0
    v_exp_f32 v1, v1
    v_smfmac_f32_32x32x32_bf16 v[48:63], v[116:119], v[24:31], v133
    s_waitcnt lgkmcnt(2)
    ds_read_b128 v[104:107], v128 offset:49152
    v_exp_f32 v2, v2
    v_exp_f32 v3, v3
    v_exp_f32 v4, v4
    v_mfma_f32_32x32x16_bf16 v[16:31], v[108:111], v[100:103], v[80:95]
    ds_read_b64_tr_b16 v[112:113], v129 offset:0
    v_exp_f32 v5, v5
    v_exp_f32 v6, v6
    v_exp_f32 v7, v7
    v_exp_f32 v8, v8
    v_exp_f32 v9, v9
    v_exp_f32 v10, v10
    v_smfmac_f32_32x32x32_bf16 v[32:47], v[120:123], v[0:7], v133
    s_waitcnt lgkmcnt(2)
    ds_read_b64_tr_b16 v[114:115], v129 offset:128
    v_exp_f32 v11, v11
    v_exp_f32 v12, v12
    v_exp_f32 v13, v13
    v_exp_f32 v14, v14
    v_exp_f32 v15, v15
    v_exp_f32 v16, v16
    v_exp_f32 v17, v17
    v_smfmac_f32_32x32x32_bf16 v[32:47], v[124:127], v[8:15], v133
    s_waitcnt lgkmcnt(2)
    ds_read_b64_tr_b16 v[116:117], v129 offset:512
    v_exp_f32 v18, v18
    v_exp_f32 v19, v19
    v_exp_f32 v20, v20
    v_mfma_f32_32x32x16_bf16 v[0:15], v[104:107], v[96:99], v[64:79]
    ds_read_b64_tr_b16 v[118:119], v129 offset:640
    v_exp_f32 v21, v21
    v_exp_f32 v22, v22
    v_exp_f32 v23, v23
    v_exp_f32 v24, v24
    v_exp_f32 v25, v25
    v_exp_f32 v26, v26
    v_smfmac_f32_32x32x32_bf16 v[48:63], v[120:123], v[16:23], v133
    v_exp_f32 v27, v27
    v_exp_f32 v28, v28
    v_exp_f32 v29, v29
    v_exp_f32 v30, v30
    v_exp_f32 v31, v31
    v_exp_f32 v0, v0
    v_exp_f32 v1, v1
    v_smfmac_f32_32x32x32_bf16 v[48:63], v[124:127], v[24:31], v133
    s_waitcnt lgkmcnt(2)
    ds_read_b128 v[108:111], v128 offset:50176
    v_exp_f32 v2, v2
    v_exp_f32 v3, v3
    v_exp_f32 v4, v4
    v_mfma_f32_32x32x16_bf16 v[16:31], v[104:107], v[100:103], v[80:95]
    ds_read_b64_tr_b16 v[120:121], v129 offset:1024
    v_exp_f32 v5, v5
    v_exp_f32 v6, v6
    v_exp_f32 v7, v7
    v_exp_f32 v8, v8
    v_exp_f32 v9, v9
    v_exp_f32 v10, v10
    v_smfmac_f32_32x32x32_bf16 v[32:47], v[112:115], v[0:7], v133
    s_waitcnt lgkmcnt(2)
    ds_read_b64_tr_b16 v[122:123], v129 offset:1152
    v_exp_f32 v11, v11
    v_exp_f32 v12, v12
    v_exp_f32 v13, v13
    v_exp_f32 v14, v14
    v_exp_f32 v15, v15
    v_exp_f32 v16, v16
    v_exp_f32 v17, v17
    v_smfmac_f32_32x32x32_bf16 v[32:47], v[116:119], v[8:15], v133
    s_waitcnt lgkmcnt(2)
    ds_read_b64_tr_b16 v[124:125], v129 offset:1536
    v_exp_f32 v18, v18
    v_exp_f32 v19, v19
    v_exp_f32 v20, v20
    v_mfma_f32_32x32x16_bf16 v[0:15], v[108:111], v[96:99], v[64:79]
    ds_read_b64_tr_b16 v[126:127], v129 offset:1664
    v_exp_f32 v21, v21
    v_exp_f32 v22, v22
    v_exp_f32 v23, v23
    v_exp_f32 v24, v24
    v_exp_f32 v25, v25
    v_exp_f32 v26, v26
    v_smfmac_f32_32x32x32_bf16 v[48:63], v[112:115], v[16:23], v133
    v_exp_f32 v27, v27
    v_exp_f32 v28, v28
    v_exp_f32 v29, v29
    v_exp_f32 v30, v30
    v_exp_f32 v31, v31
    v_exp_f32 v0, v0
    v_exp_f32 v1, v1
    v_smfmac_f32_32x32x32_bf16 v[48:63], v[116:119], v[24:31], v133
    s_waitcnt lgkmcnt(2)
    ds_read_b128 v[104:107], v128 offset:51200
    v_exp_f32 v2, v2
    v_exp_f32 v3, v3
    v_exp_f32 v4, v4
    v_mfma_f32_32x32x16_bf16 v[16:31], v[108:111], v[100:103], v[80:95]
    ds_read_b64_tr_b16 v[112:113], v129 offset:2048
    v_exp_f32 v5, v5
    v_exp_f32 v6, v6
    v_exp_f32 v7, v7
    v_exp_f32 v8, v8
    v_exp_f32 v9, v9
    v_exp_f32 v10, v10
    v_smfmac_f32_32x32x32_bf16 v[32:47], v[120:123], v[0:7], v133
    s_waitcnt lgkmcnt(2)
    ds_read_b64_tr_b16 v[114:115], v129 offset:2176
    v_exp_f32 v11, v11
    v_exp_f32 v12, v12
    v_exp_f32 v13, v13
    v_exp_f32 v14, v14
    v_exp_f32 v15, v15
    v_exp_f32 v16, v16
    v_exp_f32 v17, v17
    v_smfmac_f32_32x32x32_bf16 v[32:47], v[124:127], v[8:15], v133
    s_waitcnt lgkmcnt(2)
    ds_read_b64_tr_b16 v[116:117], v129 offset:2560
    v_exp_f32 v18, v18
    v_exp_f32 v19, v19
    v_exp_f32 v20, v20
    v_mfma_f32_32x32x16_bf16 v[0:15], v[104:107], v[96:99], v[64:79]
    ds_read_b64_tr_b16 v[118:119], v129 offset:2688
    v_exp_f32 v21, v21
    v_exp_f32 v22, v22
    v_exp_f32 v23, v23
    v_exp_f32 v24, v24
    v_exp_f32 v25, v25
    v_exp_f32 v26, v26
    v_smfmac_f32_32x32x32_bf16 v[48:63], v[120:123], v[16:23], v133
    v_exp_f32 v27, v27
    v_exp_f32 v28, v28
    v_exp_f32 v29, v29
    v_exp_f32 v30, v30
    v_exp_f32 v31, v31
    v_exp_f32 v0, v0
    v_exp_f32 v1, v1
    v_smfmac_f32_32x32x32_bf16 v[48:63], v[124:127], v[24:31], v133
    s_waitcnt lgkmcnt(2)
    ds_read_b128 v[108:111], v128 offset:52224
    v_exp_f32 v2, v2
    v_exp_f32 v3, v3
    v_exp_f32 v4, v4
    v_mfma_f32_32x32x16_bf16 v[16:31], v[104:107], v[100:103], v[80:95]
    ds_read_b64_tr_b16 v[120:121], v129 offset:3072
    v_exp_f32 v5, v5
    v_exp_f32 v6, v6
    v_exp_f32 v7, v7
    v_exp_f32 v8, v8
    v_exp_f32 v9, v9
    v_exp_f32 v10, v10
    v_smfmac_f32_32x32x32_bf16 v[32:47], v[112:115], v[0:7], v133
    s_waitcnt lgkmcnt(2)
    ds_read_b64_tr_b16 v[122:123], v129 offset:3200
    v_exp_f32 v11, v11
    v_exp_f32 v12, v12
    v_exp_f32 v13, v13
    v_exp_f32 v14, v14
    v_exp_f32 v15, v15
    v_exp_f32 v16, v16
    v_exp_f32 v17, v17
    v_smfmac_f32_32x32x32_bf16 v[32:47], v[116:119], v[8:15], v133
    s_waitcnt lgkmcnt(2)
    ds_read_b64_tr_b16 v[124:125], v129 offset:3584
    v_exp_f32 v18, v18
    v_exp_f32 v19, v19
    v_exp_f32 v20, v20
    v_mfma_f32_32x32x16_bf16 v[0:15], v[108:111], v[96:99], v[64:79]
    ds_read_b64_tr_b16 v[126:127], v129 offset:3712
    v_exp_f32 v21, v21
    v_exp_f32 v22, v22
    v_exp_f32 v23, v23
    v_exp_f32 v24, v24
    v_exp_f32 v25, v25
    v_exp_f32 v26, v26
    v_smfmac_f32_32x32x32_bf16 v[48:63], v[112:115], v[16:23], v133
    v_exp_f32 v27, v27
    v_exp_f32 v28, v28
    v_exp_f32 v29, v29
    v_exp_f32 v30, v30
    v_exp_f32 v31, v31
    v_exp_f32 v0, v0
    v_exp_f32 v1, v1
    v_smfmac_f32_32x32x32_bf16 v[48:63], v[116:119], v[24:31], v133
    s_waitcnt lgkmcnt(2)
    ds_read_b128 v[104:107], v128 offset:53248
    v_exp_f32 v2, v2
    v_exp_f32 v3, v3
    v_exp_f32 v4, v4
    v_mfma_f32_32x32x16_bf16 v[16:31], v[108:111], v[100:103], v[80:95]
    ds_read_b64_tr_b16 v[112:113], v129 offset:4096
    v_exp_f32 v5, v5
    v_exp_f32 v6, v6
    v_exp_f32 v7, v7
    v_exp_f32 v8, v8
    v_exp_f32 v9, v9
    v_exp_f32 v10, v10
    v_smfmac_f32_32x32x32_bf16 v[32:47], v[120:123], v[0:7], v133
    s_waitcnt lgkmcnt(2)
    ds_read_b64_tr_b16 v[114:115], v129 offset:4224
    v_exp_f32 v11, v11
    v_exp_f32 v12, v12
    v_exp_f32 v13, v13
    v_exp_f32 v14, v14
    v_exp_f32 v15, v15
    v_exp_f32 v16, v16
    v_exp_f32 v17, v17
    v_smfmac_f32_32x32x32_bf16 v[32:47], v[124:127], v[8:15], v133
    s_waitcnt lgkmcnt(2)
    ds_read_b64_tr_b16 v[116:117], v129 offset:4608
    v_exp_f32 v18, v18
    v_exp_f32 v19, v19
    v_exp_f32 v20, v20
    v_mfma_f32_32x32x16_bf16 v[0:15], v[104:107], v[96:99], v[64:79]
    ds_read_b64_tr_b16 v[118:119], v129 offset:4736
    v_exp_f32 v21, v21
    v_exp_f32 v22, v22
    v_exp_f32 v23, v23
    v_exp_f32 v24, v24
    v_exp_f32 v25, v25
    v_exp_f32 v26, v26
    v_smfmac_f32_32x32x32_bf16 v[48:63], v[120:123], v[16:23], v133
    s_cbranch_scc0 L_skip103
    s_setprio 0
L_skip103:
    v_exp_f32 v27, v27
    v_exp_f32 v28, v28
    v_exp_f32 v29, v29
    v_exp_f32 v30, v30
    v_exp_f32 v31, v31
    v_exp_f32 v0, v0
    v_exp_f32 v1, v1
    v_smfmac_f32_32x32x32_bf16 v[48:63], v[124:127], v[24:31], v133
    s_waitcnt lgkmcnt(2)
    ds_read_b128 v[108:111], v128 offset:54272
    v_exp_f32 v2, v2
    v_exp_f32 v3, v3
    v_exp_f32 v4, v4
    v_mfma_f32_32x32x16_bf16 v[16:31], v[104:107], v[100:103], v[80:95]
    ds_read_b64_tr_b16 v[120:121], v129 offset:5120
    v_exp_f32 v5, v5
    v_exp_f32 v6, v6
    v_exp_f32 v7, v7
    v_exp_f32 v8, v8
    v_exp_f32 v9, v9
    v_exp_f32 v10, v10
    v_smfmac_f32_32x32x32_bf16 v[32:47], v[112:115], v[0:7], v133
    s_waitcnt lgkmcnt(2)
    ds_read_b64_tr_b16 v[122:123], v129 offset:5248
    v_exp_f32 v11, v11
    v_exp_f32 v12, v12
    v_exp_f32 v13, v13
    v_exp_f32 v14, v14
    v_exp_f32 v15, v15
    v_exp_f32 v16, v16
    v_exp_f32 v17, v17
    v_smfmac_f32_32x32x32_bf16 v[32:47], v[116:119], v[8:15], v133
    s_waitcnt lgkmcnt(2)
    ds_read_b64_tr_b16 v[124:125], v129 offset:5632
    v_exp_f32 v18, v18
    v_exp_f32 v19, v19
    v_exp_f32 v20, v20
    v_mfma_f32_32x32x16_bf16 v[0:15], v[108:111], v[96:99], v[64:79]
    ds_read_b64_tr_b16 v[126:127], v129 offset:5760
    v_exp_f32 v21, v21
    v_exp_f32 v22, v22
    v_exp_f32 v23, v23
    v_exp_f32 v24, v24
    v_exp_f32 v25, v25
    v_exp_f32 v26, v26
    v_smfmac_f32_32x32x32_bf16 v[48:63], v[112:115], v[16:23], v133
    v_exp_f32 v27, v27
    v_exp_f32 v28, v28
    v_exp_f32 v29, v29
    v_exp_f32 v30, v30
    v_exp_f32 v31, v31
    v_exp_f32 v0, v0
    v_exp_f32 v1, v1
    v_smfmac_f32_32x32x32_bf16 v[48:63], v[116:119], v[24:31], v133
    s_waitcnt lgkmcnt(2)
    ds_read_b128 v[104:107], v128 offset:55296
    v_exp_f32 v2, v2
    v_exp_f32 v3, v3
    v_exp_f32 v4, v4
    v_mfma_f32_32x32x16_bf16 v[16:31], v[108:111], v[100:103], v[80:95]
    ds_read_b64_tr_b16 v[112:113], v129 offset:6144
    v_exp_f32 v5, v5
    v_exp_f32 v6, v6
    v_exp_f32 v7, v7
    v_exp_f32 v8, v8
    v_exp_f32 v9, v9
    v_exp_f32 v10, v10
    v_smfmac_f32_32x32x32_bf16 v[32:47], v[120:123], v[0:7], v133
    s_waitcnt lgkmcnt(2)
    ds_read_b64_tr_b16 v[114:115], v129 offset:6272
    v_exp_f32 v11, v11
    v_exp_f32 v12, v12
    v_exp_f32 v13, v13
    v_exp_f32 v14, v14
    v_exp_f32 v15, v15
    v_exp_f32 v16, v16
    v_exp_f32 v17, v17
    v_smfmac_f32_32x32x32_bf16 v[32:47], v[124:127], v[8:15], v133
    s_waitcnt lgkmcnt(2)
    ds_read_b64_tr_b16 v[116:117], v129 offset:6656
    v_exp_f32 v18, v18
    v_exp_f32 v19, v19
    v_exp_f32 v20, v20
    v_mfma_f32_32x32x16_bf16 v[0:15], v[104:107], v[96:99], v[64:79]
    ds_read_b64_tr_b16 v[118:119], v129 offset:6784
    v_exp_f32 v21, v21
    v_exp_f32 v22, v22
    v_exp_f32 v23, v23
    v_exp_f32 v24, v24
    v_exp_f32 v25, v25
    v_exp_f32 v26, v26
    v_smfmac_f32_32x32x32_bf16 v[48:63], v[120:123], v[16:23], v133
    v_exp_f32 v27, v27
    v_exp_f32 v28, v28
    v_exp_f32 v29, v29
    v_exp_f32 v30, v30
    v_exp_f32 v31, v31
    v_exp_f32 v0, v0
    v_exp_f32 v1, v1
    v_smfmac_f32_32x32x32_bf16 v[48:63], v[124:127], v[24:31], v133
    s_waitcnt lgkmcnt(2)
    ds_read_b128 v[108:111], v128 offset:56320
    v_exp_f32 v2, v2
    v_exp_f32 v3, v3
    v_exp_f32 v4, v4
    v_mfma_f32_32x32x16_bf16 v[16:31], v[104:107], v[100:103], v[80:95]
    ds_read_b64_tr_b16 v[120:121], v129 offset:7168
    v_exp_f32 v5, v5
    v_exp_f32 v6, v6
    v_exp_f32 v7, v7
    v_exp_f32 v8, v8
    v_exp_f32 v9, v9
    v_exp_f32 v10, v10
    v_smfmac_f32_32x32x32_bf16 v[32:47], v[112:115], v[0:7], v133
    s_waitcnt lgkmcnt(2)
    ds_read_b64_tr_b16 v[122:123], v129 offset:7296
    v_exp_f32 v11, v11
    v_exp_f32 v12, v12
    v_exp_f32 v13, v13
    v_exp_f32 v14, v14
    v_exp_f32 v15, v15
    v_exp_f32 v16, v16
    v_exp_f32 v17, v17
    v_smfmac_f32_32x32x32_bf16 v[32:47], v[116:119], v[8:15], v133
    s_waitcnt lgkmcnt(2)
    ds_read_b64_tr_b16 v[124:125], v129 offset:7680
    v_exp_f32 v18, v18
    v_exp_f32 v19, v19
    v_exp_f32 v20, v20
    v_mfma_f32_32x32x16_bf16 v[0:15], v[108:111], v[96:99], v[64:79]
    ds_read_b64_tr_b16 v[126:127], v129 offset:7808
    v_exp_f32 v21, v21
    v_exp_f32 v22, v22
    v_exp_f32 v23, v23
    v_exp_f32 v24, v24
    v_exp_f32 v25, v25
    v_exp_f32 v26, v26
    v_smfmac_f32_32x32x32_bf16 v[48:63], v[112:115], v[16:23], v133
    v_add_u32 v129, v130, v129
    v_exp_f32 v27, v27
    v_exp_f32 v28, v28
    v_exp_f32 v29, v29
    v_exp_f32 v30, v30
    v_exp_f32 v31, v31
    v_exp_f32 v0, v0
    v_exp_f32 v1, v1
    v_smfmac_f32_32x32x32_bf16 v[48:63], v[116:119], v[24:31], v133
    s_waitcnt lgkmcnt(2)
    ds_read_b128 v[104:107], v128 offset:57344
    v_exp_f32 v2, v2
    v_exp_f32 v3, v3
    v_exp_f32 v4, v4
    v_mfma_f32_32x32x16_bf16 v[16:31], v[108:111], v[100:103], v[80:95]
    ds_read_b64_tr_b16 v[112:113], v129 offset:0
    v_exp_f32 v5, v5
    v_exp_f32 v6, v6
    v_exp_f32 v7, v7
    v_exp_f32 v8, v8
    v_exp_f32 v9, v9
    v_exp_f32 v10, v10
    v_smfmac_f32_32x32x32_bf16 v[32:47], v[120:123], v[0:7], v133
    s_waitcnt lgkmcnt(2)
    ds_read_b64_tr_b16 v[114:115], v129 offset:128
    v_exp_f32 v11, v11
    v_exp_f32 v12, v12
    v_exp_f32 v13, v13
    v_exp_f32 v14, v14
    v_exp_f32 v15, v15
    v_exp_f32 v16, v16
    v_exp_f32 v17, v17
    v_smfmac_f32_32x32x32_bf16 v[32:47], v[124:127], v[8:15], v133
    s_waitcnt lgkmcnt(2)
    ds_read_b64_tr_b16 v[116:117], v129 offset:512
    v_exp_f32 v18, v18
    v_exp_f32 v19, v19
    v_exp_f32 v20, v20
    v_mfma_f32_32x32x16_bf16 v[0:15], v[104:107], v[96:99], v[64:79]
    ds_read_b64_tr_b16 v[118:119], v129 offset:640
    v_exp_f32 v21, v21
    v_exp_f32 v22, v22
    v_exp_f32 v23, v23
    v_exp_f32 v24, v24
    v_exp_f32 v25, v25
    v_exp_f32 v26, v26
    v_smfmac_f32_32x32x32_bf16 v[48:63], v[120:123], v[16:23], v133
    v_exp_f32 v27, v27
    v_exp_f32 v28, v28
    v_exp_f32 v29, v29
    v_exp_f32 v30, v30
    v_exp_f32 v31, v31
    v_exp_f32 v0, v0
    v_exp_f32 v1, v1
    v_smfmac_f32_32x32x32_bf16 v[48:63], v[124:127], v[24:31], v133
    s_waitcnt lgkmcnt(2)
    ds_read_b128 v[108:111], v128 offset:58368
    v_exp_f32 v2, v2
    v_exp_f32 v3, v3
    v_exp_f32 v4, v4
    v_mfma_f32_32x32x16_bf16 v[16:31], v[104:107], v[100:103], v[80:95]
    ds_read_b64_tr_b16 v[120:121], v129 offset:1024
    v_exp_f32 v5, v5
    v_exp_f32 v6, v6
    v_exp_f32 v7, v7
    v_exp_f32 v8, v8
    v_exp_f32 v9, v9
    v_exp_f32 v10, v10
    v_smfmac_f32_32x32x32_bf16 v[32:47], v[112:115], v[0:7], v133
    s_waitcnt lgkmcnt(2)
    ds_read_b64_tr_b16 v[122:123], v129 offset:1152
    v_exp_f32 v11, v11
    v_exp_f32 v12, v12
    v_exp_f32 v13, v13
    v_exp_f32 v14, v14
    v_exp_f32 v15, v15
    v_exp_f32 v16, v16
    v_exp_f32 v17, v17
    v_smfmac_f32_32x32x32_bf16 v[32:47], v[116:119], v[8:15], v133
    s_waitcnt lgkmcnt(2)
    ds_read_b64_tr_b16 v[124:125], v129 offset:1536
    v_exp_f32 v18, v18
    v_exp_f32 v19, v19
    v_exp_f32 v20, v20
    v_mfma_f32_32x32x16_bf16 v[0:15], v[108:111], v[96:99], v[64:79]
    ds_read_b64_tr_b16 v[126:127], v129 offset:1664
    v_exp_f32 v21, v21
    v_exp_f32 v22, v22
    v_exp_f32 v23, v23
    v_exp_f32 v24, v24
    v_exp_f32 v25, v25
    v_exp_f32 v26, v26
    v_smfmac_f32_32x32x32_bf16 v[48:63], v[112:115], v[16:23], v133
    v_exp_f32 v27, v27
    v_exp_f32 v28, v28
    v_exp_f32 v29, v29
    v_exp_f32 v30, v30
    v_exp_f32 v31, v31
    v_exp_f32 v0, v0
    v_exp_f32 v1, v1
    v_smfmac_f32_32x32x32_bf16 v[48:63], v[116:119], v[24:31], v133
    s_waitcnt lgkmcnt(2)
    ds_read_b128 v[104:107], v128 offset:59392
    v_exp_f32 v2, v2
    v_exp_f32 v3, v3
    v_exp_f32 v4, v4
    v_mfma_f32_32x32x16_bf16 v[16:31], v[108:111], v[100:103], v[80:95]
    ds_read_b64_tr_b16 v[112:113], v129 offset:2048
    v_exp_f32 v5, v5
    v_exp_f32 v6, v6
    v_exp_f32 v7, v7
    v_exp_f32 v8, v8
    v_exp_f32 v9, v9
    v_exp_f32 v10, v10
    v_smfmac_f32_32x32x32_bf16 v[32:47], v[120:123], v[0:7], v133
    s_waitcnt lgkmcnt(2)
    ds_read_b64_tr_b16 v[114:115], v129 offset:2176
    v_exp_f32 v11, v11
    v_exp_f32 v12, v12
    v_exp_f32 v13, v13
    v_exp_f32 v14, v14
    v_exp_f32 v15, v15
    v_exp_f32 v16, v16
    v_exp_f32 v17, v17
    v_smfmac_f32_32x32x32_bf16 v[32:47], v[124:127], v[8:15], v133
    s_waitcnt lgkmcnt(2)
    ds_read_b64_tr_b16 v[116:117], v129 offset:2560
    v_exp_f32 v18, v18
    v_exp_f32 v19, v19
    v_exp_f32 v20, v20
    v_mfma_f32_32x32x16_bf16 v[0:15], v[104:107], v[96:99], v[64:79]
    ds_read_b64_tr_b16 v[118:119], v129 offset:2688
    v_exp_f32 v21, v21
    v_exp_f32 v22, v22
    v_exp_f32 v23, v23
    v_exp_f32 v24, v24
    v_exp_f32 v25, v25
    v_exp_f32 v26, v26
    v_smfmac_f32_32x32x32_bf16 v[48:63], v[120:123], v[16:23], v133
    v_exp_f32 v27, v27
    v_exp_f32 v28, v28
    v_exp_f32 v29, v29
    v_exp_f32 v30, v30
    v_exp_f32 v31, v31
    v_exp_f32 v0, v0
    v_exp_f32 v1, v1
    v_smfmac_f32_32x32x32_bf16 v[48:63], v[124:127], v[24:31], v133
    s_waitcnt lgkmcnt(2)
    ds_read_b128 v[108:111], v128 offset:60416
    v_exp_f32 v2, v2
    v_exp_f32 v3, v3
    v_exp_f32 v4, v4
    v_mfma_f32_32x32x16_bf16 v[16:31], v[104:107], v[100:103], v[80:95]
    ds_read_b64_tr_b16 v[120:121], v129 offset:3072
    v_exp_f32 v5, v5
    v_exp_f32 v6, v6
    v_exp_f32 v7, v7
    v_exp_f32 v8, v8
    v_exp_f32 v9, v9
    v_exp_f32 v10, v10
    v_smfmac_f32_32x32x32_bf16 v[32:47], v[112:115], v[0:7], v133
    s_waitcnt lgkmcnt(2)
    ds_read_b64_tr_b16 v[122:123], v129 offset:3200
    v_exp_f32 v11, v11
    v_exp_f32 v12, v12
    v_exp_f32 v13, v13
    v_exp_f32 v14, v14
    v_exp_f32 v15, v15
    v_exp_f32 v16, v16
    v_exp_f32 v17, v17
    v_smfmac_f32_32x32x32_bf16 v[32:47], v[116:119], v[8:15], v133
    s_waitcnt lgkmcnt(2)
    ds_read_b64_tr_b16 v[124:125], v129 offset:3584
    v_exp_f32 v18, v18
    v_exp_f32 v19, v19
    v_exp_f32 v20, v20
    v_mfma_f32_32x32x16_bf16 v[0:15], v[108:111], v[96:99], v[64:79]
    ds_read_b64_tr_b16 v[126:127], v129 offset:3712
    v_exp_f32 v21, v21
    v_exp_f32 v22, v22
    v_exp_f32 v23, v23
    v_exp_f32 v24, v24
    v_exp_f32 v25, v25
    v_exp_f32 v26, v26
    v_smfmac_f32_32x32x32_bf16 v[48:63], v[112:115], v[16:23], v133
    v_exp_f32 v27, v27
    v_exp_f32 v28, v28
    v_exp_f32 v29, v29
    v_exp_f32 v30, v30
    v_exp_f32 v31, v31
    v_exp_f32 v0, v0
    v_exp_f32 v1, v1
    v_smfmac_f32_32x32x32_bf16 v[48:63], v[116:119], v[24:31], v133
    s_waitcnt lgkmcnt(2)
    ds_read_b128 v[104:107], v128 offset:61440
    v_exp_f32 v2, v2
    v_exp_f32 v3, v3
    v_exp_f32 v4, v4
    v_mfma_f32_32x32x16_bf16 v[16:31], v[108:111], v[100:103], v[80:95]
    ds_read_b64_tr_b16 v[112:113], v129 offset:4096
    v_exp_f32 v5, v5
    v_exp_f32 v6, v6
    v_exp_f32 v7, v7
    v_exp_f32 v8, v8
    v_exp_f32 v9, v9
    v_exp_f32 v10, v10
    v_smfmac_f32_32x32x32_bf16 v[32:47], v[120:123], v[0:7], v133
    s_waitcnt lgkmcnt(2)
    ds_read_b64_tr_b16 v[114:115], v129 offset:4224
    v_exp_f32 v11, v11
    v_exp_f32 v12, v12
    v_exp_f32 v13, v13
    v_exp_f32 v14, v14
    v_exp_f32 v15, v15
    v_exp_f32 v16, v16
    v_exp_f32 v17, v17
    v_smfmac_f32_32x32x32_bf16 v[32:47], v[124:127], v[8:15], v133
    s_waitcnt lgkmcnt(2)
    ds_read_b64_tr_b16 v[116:117], v129 offset:4608
    v_exp_f32 v18, v18
    v_exp_f32 v19, v19
    v_exp_f32 v20, v20
    v_mfma_f32_32x32x16_bf16 v[0:15], v[104:107], v[96:99], v[64:79]
    ds_read_b64_tr_b16 v[118:119], v129 offset:4736
    v_exp_f32 v21, v21
    v_exp_f32 v22, v22
    v_exp_f32 v23, v23
    v_exp_f32 v24, v24
    v_exp_f32 v25, v25
    v_exp_f32 v26, v26
    v_smfmac_f32_32x32x32_bf16 v[48:63], v[120:123], v[16:23], v133
    v_exp_f32 v27, v27
    v_exp_f32 v28, v28
    v_exp_f32 v29, v29
    v_exp_f32 v30, v30
    v_exp_f32 v31, v31
    v_exp_f32 v0, v0
    v_exp_f32 v1, v1
    v_smfmac_f32_32x32x32_bf16 v[48:63], v[124:127], v[24:31], v133
    s_waitcnt lgkmcnt(2)
    ds_read_b128 v[108:111], v128 offset:62464
    v_exp_f32 v2, v2
    v_exp_f32 v3, v3
    v_exp_f32 v4, v4
    v_mfma_f32_32x32x16_bf16 v[16:31], v[104:107], v[100:103], v[80:95]
    ds_read_b64_tr_b16 v[120:121], v129 offset:5120
    v_exp_f32 v5, v5
    v_exp_f32 v6, v6
    v_exp_f32 v7, v7
    v_exp_f32 v8, v8
    v_exp_f32 v9, v9
    v_exp_f32 v10, v10
    v_smfmac_f32_32x32x32_bf16 v[32:47], v[112:115], v[0:7], v133
    s_waitcnt lgkmcnt(2)
    ds_read_b64_tr_b16 v[122:123], v129 offset:5248
    v_exp_f32 v11, v11
    v_exp_f32 v12, v12
    v_exp_f32 v13, v13
    v_exp_f32 v14, v14
    v_exp_f32 v15, v15
    v_exp_f32 v16, v16
    v_exp_f32 v17, v17
    v_smfmac_f32_32x32x32_bf16 v[32:47], v[116:119], v[8:15], v133
    s_waitcnt lgkmcnt(2)
    ds_read_b64_tr_b16 v[124:125], v129 offset:5632
    v_exp_f32 v18, v18
    v_exp_f32 v19, v19
    v_exp_f32 v20, v20
    v_mfma_f32_32x32x16_bf16 v[0:15], v[108:111], v[96:99], v[64:79]
    ds_read_b64_tr_b16 v[126:127], v129 offset:5760
    v_exp_f32 v21, v21
    v_exp_f32 v22, v22
    v_exp_f32 v23, v23
    v_exp_f32 v24, v24
    v_exp_f32 v25, v25
    v_exp_f32 v26, v26
    v_smfmac_f32_32x32x32_bf16 v[48:63], v[112:115], v[16:23], v133
    v_exp_f32 v27, v27
    v_exp_f32 v28, v28
    v_exp_f32 v29, v29
    v_exp_f32 v30, v30
    v_exp_f32 v31, v31
    v_exp_f32 v0, v0
    v_exp_f32 v1, v1
    v_smfmac_f32_32x32x32_bf16 v[48:63], v[116:119], v[24:31], v133
    s_waitcnt lgkmcnt(2)
    ds_read_b128 v[104:107], v128 offset:63488
    v_exp_f32 v2, v2
    v_exp_f32 v3, v3
    v_exp_f32 v4, v4
    v_mfma_f32_32x32x16_bf16 v[16:31], v[108:111], v[100:103], v[80:95]
    ds_read_b64_tr_b16 v[112:113], v129 offset:6144
    v_exp_f32 v5, v5
    v_exp_f32 v6, v6
    v_exp_f32 v7, v7
    v_exp_f32 v8, v8
    v_exp_f32 v9, v9
    v_exp_f32 v10, v10
    v_smfmac_f32_32x32x32_bf16 v[32:47], v[120:123], v[0:7], v133
    s_waitcnt lgkmcnt(2)
    ds_read_b64_tr_b16 v[114:115], v129 offset:6272
    v_exp_f32 v11, v11
    v_exp_f32 v12, v12
    v_exp_f32 v13, v13
    v_exp_f32 v14, v14
    v_exp_f32 v15, v15
    v_exp_f32 v16, v16
    v_exp_f32 v17, v17
    v_smfmac_f32_32x32x32_bf16 v[32:47], v[124:127], v[8:15], v133
    s_waitcnt lgkmcnt(2)
    ds_read_b64_tr_b16 v[116:117], v129 offset:6656
    v_exp_f32 v18, v18
    v_exp_f32 v19, v19
    v_exp_f32 v20, v20
    v_mfma_f32_32x32x16_bf16 v[0:15], v[104:107], v[96:99], v[64:79]
    ds_read_b64_tr_b16 v[118:119], v129 offset:6784
    v_exp_f32 v21, v21
    v_exp_f32 v22, v22
    v_exp_f32 v23, v23
    v_exp_f32 v24, v24
    v_exp_f32 v25, v25
    v_exp_f32 v26, v26
    v_smfmac_f32_32x32x32_bf16 v[48:63], v[120:123], v[16:23], v133
    v_exp_f32 v27, v27
    v_exp_f32 v28, v28
    v_exp_f32 v29, v29
    v_exp_f32 v30, v30
    v_exp_f32 v31, v31
    v_exp_f32 v0, v0
    v_exp_f32 v1, v1
    v_smfmac_f32_32x32x32_bf16 v[48:63], v[124:127], v[24:31], v133
    s_waitcnt lgkmcnt(2)
    ds_read_b128 v[108:111], v128 offset:64512
    v_exp_f32 v2, v2
    v_exp_f32 v3, v3
    v_exp_f32 v4, v4
    v_mfma_f32_32x32x16_bf16 v[16:31], v[104:107], v[100:103], v[80:95]
    ds_read_b64_tr_b16 v[120:121], v129 offset:7168
    v_exp_f32 v5, v5
    v_exp_f32 v6, v6
    v_exp_f32 v7, v7
    v_exp_f32 v8, v8
    v_exp_f32 v9, v9
    v_exp_f32 v10, v10
    v_smfmac_f32_32x32x32_bf16 v[32:47], v[112:115], v[0:7], v133
    s_waitcnt lgkmcnt(2)
    ds_read_b64_tr_b16 v[122:123], v129 offset:7296
    v_exp_f32 v11, v11
    v_exp_f32 v12, v12
    v_exp_f32 v13, v13
    v_exp_f32 v14, v14
    v_exp_f32 v15, v15
    v_exp_f32 v16, v16
    v_exp_f32 v17, v17
    v_smfmac_f32_32x32x32_bf16 v[32:47], v[116:119], v[8:15], v133
    s_waitcnt lgkmcnt(2)
    ds_read_b64_tr_b16 v[124:125], v129 offset:7680
    v_exp_f32 v18, v18
    v_exp_f32 v19, v19
    v_exp_f32 v20, v20
    v_mfma_f32_32x32x16_bf16 v[0:15], v[108:111], v[96:99], v[64:79]
    ds_read_b64_tr_b16 v[126:127], v129 offset:7808
    v_exp_f32 v21, v21
    v_exp_f32 v22, v22
    v_exp_f32 v23, v23
    v_exp_f32 v24, v24
    v_exp_f32 v25, v25
    v_exp_f32 v26, v26
    v_smfmac_f32_32x32x32_bf16 v[48:63], v[112:115], v[16:23], v133
    v_exp_f32 v27, v27
    v_exp_f32 v28, v28
    v_exp_f32 v29, v29
    v_exp_f32 v30, v30
    v_exp_f32 v31, v31
    v_exp_f32 v0, v0
    v_exp_f32 v1, v1
    v_smfmac_f32_32x32x32_bf16 v[48:63], v[116:119], v[24:31], v133
    s_waitcnt lgkmcnt(2)
    v_exp_f32 v2, v2
    v_exp_f32 v3, v3
    v_exp_f32 v4, v4
    v_mfma_f32_32x32x16_bf16 v[16:31], v[108:111], v[100:103], v[80:95]
    v_exp_f32 v5, v5
    v_exp_f32 v6, v6
    v_exp_f32 v7, v7
    v_exp_f32 v8, v8
    v_exp_f32 v9, v9
    v_exp_f32 v10, v10
    v_smfmac_f32_32x32x32_bf16 v[32:47], v[120:123], v[0:7], v133
    s_waitcnt lgkmcnt(0)
    v_exp_f32 v11, v11
    v_exp_f32 v12, v12
    v_exp_f32 v13, v13
    v_exp_f32 v14, v14
    v_exp_f32 v15, v15
    v_exp_f32 v16, v16
    v_exp_f32 v17, v17
    v_smfmac_f32_32x32x32_bf16 v[32:47], v[124:127], v[8:15], v133
    v_exp_f32 v18, v18
    v_exp_f32 v19, v19
    v_exp_f32 v20, v20
    v_exp_f32 v21, v21
    v_exp_f32 v22, v22
    v_exp_f32 v23, v23
    v_exp_f32 v24, v24
    v_exp_f32 v25, v25
    v_exp_f32 v26, v26
    v_smfmac_f32_32x32x32_bf16 v[48:63], v[120:123], v[16:23], v133
    v_exp_f32 v27, v27
    v_exp_f32 v28, v28
    v_exp_f32 v29, v29
    v_exp_f32 v30, v30
    v_exp_f32 v31, v31
    s_setprio 3
    v_rcp_f32 v138, v40
    v_smfmac_f32_32x32x32_bf16 v[48:63], v[124:127], v[24:31], v133
L_epi:
    v_pk_mul_f32 v[32:33], v[32:33], v[138:139] op_sel_hi:[1,0]
    v_pk_mul_f32 v[34:35], v[34:35], v[138:139] op_sel_hi:[1,0]
    v_pk_mul_f32 v[36:37], v[36:37], v[138:139] op_sel_hi:[1,0]
    v_pk_mul_f32 v[38:39], v[38:39], v[138:139] op_sel_hi:[1,0]
    v_cvt_pk_bf16_f32 v4, v32, v33
    v_cvt_pk_bf16_f32 v5, v34, v35
    v_cvt_pk_bf16_f32 v6, v36, v37
    v_cvt_pk_bf16_f32 v7, v38, v39
    buffer_store_dwordx4 v[4:7], v131, s[20:23], s30 offen sc0 sc1
    v_pk_add_f32 v[0:1], v[32:33], v[34:35]
    v_pk_add_f32 v[2:3], v[36:37], v[38:39]
    v_pk_add_f32 v[0:1], v[0:1], v[2:3]
    v_rcp_f32 v140, v56
    v_add_f32 v0, v0, v1
    v_pk_mul_f32 v[48:49], v[48:49], v[140:141] op_sel_hi:[1,0]
    v_pk_mul_f32 v[50:51], v[50:51], v[140:141] op_sel_hi:[1,0]
    v_pk_mul_f32 v[52:53], v[52:53], v[140:141] op_sel_hi:[1,0]
    v_pk_mul_f32 v[54:55], v[54:55], v[140:141] op_sel_hi:[1,0]
    v_cvt_pk_bf16_f32 v12, v48, v49
    v_cvt_pk_bf16_f32 v13, v50, v51
    v_cvt_pk_bf16_f32 v14, v52, v53
    v_cvt_pk_bf16_f32 v15, v54, v55
    buffer_store_dwordx4 v[12:15], v131, s[20:23], s30 offen offset:1024 sc0 sc1
    v_mov_b32 v136, 0x46000000
    v_fma_f32 v0, v0, 0, v40
    v_subrev_u32 v0, 0x35800000, v0
    v_pk_add_f32 v[8:9], v[48:49], v[50:51]
    v_pk_add_f32 v[10:11], v[52:53], v[54:55]
    v_pk_add_f32 v[8:9], v[8:9], v[10:11]
    v_add_f32 v8, v8, v9
    v_fma_f32 v8, v8, 0, v56
    v_subrev_u32 v8, 0x35800000, v8
    v_max_u32 v0, v0, v8
    v_cmp_ge_u32 vcc, v0, v136
    s_cbranch_vccnz L_redo
L_store:
L_end:
    s_endpgm
L_loader:
    buffer_load_dwordx4 v132, s[16:19], s31 offen nt lds
    buffer_load_dwordx4 v132, s[16:19], s31 offen offset:1024 nt lds
    s_add_u32 m0, m0, 0x1000
    s_add_u32 s31, s31, 0x1000
    s_cmp_lg_u32 s28, 7
    s_cbranch_scc1 L_noones
    v_lshlrev_b32 v136, 7, v135
    v_add_u32 v136, 131072, v136
    v_mov_b32 v112, 0x3f80
    v_mov_b32 v113, 0
    v_mov_b64 v[114:115], 0
    ds_write_b128 v136, v[112:115]
L_noones:
    s_waitcnt vmcnt(2) lgkmcnt(0)
    s_barrier
    s_mov_b32 s12, s4
    s_and_b32 s13, s5, 0xffff
    buffer_load_dwordx4 v[96:99], v131, s[12:15], s30 offen nt
    s_mov_b32 s24, s6
    s_and_b32 s25, s7, 0xffff
    buffer_load_dwordx4 v[104:107], v131, s[24:27], s29 offen nt
    buffer_load_dwordx4 v[100:103], v131, s[12:15], s30 offen offset:1024 nt
    buffer_load_dwordx4 v132, s[16:19], s31 offen nt lds
    buffer_load_dwordx4 v132, s[16:19], s31 offen offset:1024 nt lds
    s_add_u32 m0, m0, 0x1000
    s_add_u32 s31, s31, 0x1000
    buffer_load_dwordx4 v132, s[16:19], s31 offen nt lds
    buffer_load_dwordx4 v132, s[16:19], s31 offen offset:1024 nt lds
    s_add_u32 m0, m0, 0x1000
    s_add_u32 s31, s31, 0x1000
    s_waitcnt vmcnt(7)
    s_barrier
    buffer_load_dwordx4 v132, s[16:19], s31 offen nt lds
    buffer_load_dwordx4 v132, s[16:19], s31 offen offset:1024 nt lds
    s_add_u32 m0, m0, 0x1000
    s_add_u32 s31, s31, 0x1000
    buffer_load_dwordx4 v132, s[16:19], s31 offen nt lds
    buffer_load_dwordx4 v132, s[16:19], s31 offen offset:1024 nt lds
    s_add_u32 m0, m0, 0x1000
    s_add_u32 s31, s31, 0x1000
    buffer_load_dwordx4 v132, s[16:19], s31 offen nt lds
    buffer_load_dwordx4 v132, s[16:19], s31 offen offset:1024 nt lds
    s_add_u32 m0, m0, 0x1000
    s_add_u32 s31, s31, 0x1000
    buffer_load_dwordx4 v132, s[16:19], s31 offen nt lds
    buffer_load_dwordx4 v132, s[16:19], s31 offen offset:1024 nt lds
    s_add_u32 m0, m0, 0x1000
    s_add_u32 s31, s31, 0x1000
    s_waitcnt vmcnt(12)
    s_cmp_lt_u32 s28, 4
    s_branch L_q
L_prio_b:
    s_waitcnt vmcnt(8)
    s_barrier
    buffer_load_dwordx4 v132, s[16:19], s31 offen nt lds
    buffer_load_dwordx4 v132, s[16:19], s31 offen offset:1024 nt lds
    s_add_u32 m0, m0, 0x1000
    s_add_u32 s31, s31, 0x1000
    buffer_load_dwordx4 v132, s[16:19], s31 offen nt lds
    buffer_load_dwordx4 v132, s[16:19], s31 offen offset:1024 nt lds
    s_add_u32 m0, m0, 0x1000
    s_add_u32 s31, s31, 0x1000
    buffer_load_dwordx4 v132, s[16:19], s31 offen nt lds
    buffer_load_dwordx4 v132, s[16:19], s31 offen offset:1024 nt lds
    s_add_u32 m0, m0, 0x1000
    s_add_u32 s31, s31, 0x1000
    buffer_load_dwordx4 v132, s[16:19], s31 offen nt lds
    buffer_load_dwordx4 v132, s[16:19], s31 offen offset:1024 nt lds
    s_add_u32 m0, m0, 0x1000
    s_add_u32 s31, s31, 0x1000
    buffer_load_dwordx4 v132, s[16:19], s31 offen nt lds
    buffer_load_dwordx4 v132, s[16:19], s31 offen offset:1024 nt lds
    s_add_u32 m0, m0, 0x1000
    s_add_u32 s31, s31, 0x1000
    buffer_load_dwordx4 v132, s[16:19], s31 offen nt lds
    buffer_load_dwordx4 v132, s[16:19], s31 offen offset:1024 nt lds
    s_add_u32 m0, m0, 0x1000
    s_add_u32 s31, s31, 0x1000
    buffer_load_dwordx4 v132, s[16:19], s31 offen nt lds
    buffer_load_dwordx4 v132, s[16:19], s31 offen offset:1024 nt lds
    s_add_u32 m0, m0, 0x1000
    s_add_u32 s31, s31, 0x1000
    buffer_load_dwordx4 v132, s[16:19], s31 offen nt lds
    buffer_load_dwordx4 v132, s[16:19], s31 offen offset:1024 nt lds
    s_cmp_lt_u32 s28, 4
    s_branch L_go
L_site2:
    s_waitcnt vmcnt(16)
    s_barrier
    s_branch L_back2
L_site7:
    s_waitcnt vmcnt(0)
    s_barrier
    s_branch L_back7
L_redo:
    s_cmp_lg_u32 s37, 0
    s_cbranch_scc1 L_store
    s_mov_b32 s37, 1
    s_waitcnt vmcnt(0)
    s_mov_b32 s36, 64
    v_mov_b32 v128, v143
    v_mov_b32 v138, 0xff800000
    v_mov_b32 v140, 0xff800000
L_maxloop:
    ds_read_b128 v[104:107], v128
    v_add_u32 v128, 1024, v128
    s_sub_u32 s36, s36, 1
    s_waitcnt lgkmcnt(0)
    v_mfma_f32_32x32x16_bf16 v[0:15], v[104:107], v[96:99], 0
    v_mfma_f32_32x32x16_bf16 v[16:31], v[104:107], v[100:103], 0
    s_nop 11
    v_max3_f32 v138, v0, v1, v138
    v_max3_f32 v138, v2, v3, v138
    v_max3_f32 v138, v4, v5, v138
    v_max3_f32 v138, v6, v7, v138
    v_max3_f32 v138, v8, v9, v138
    v_max3_f32 v138, v10, v11, v138
    v_max3_f32 v138, v12, v13, v138
    v_max3_f32 v138, v14, v15, v138
    s_nop 3
    v_max3_f32 v140, v16, v17, v140
    v_max3_f32 v140, v18, v19, v140
    v_max3_f32 v140, v20, v21, v140
    v_max3_f32 v140, v22, v23, v140
    v_max3_f32 v140, v24, v25, v140
    v_max3_f32 v140, v26, v27, v140
    v_max3_f32 v140, v28, v29, v140
    v_max3_f32 v140, v30, v31, v140
    s_cmp_lg_u32 s36, 0
    s_cbranch_scc1 L_maxloop
    v_mov_b32 v134, v138
    v_mov_b32 v135, v140
    v_mov_b32 v128, v143
    v_mov_b32 v129, v142
    v_permlane32_swap_b32 v138, v134
    v_permlane32_swap_b32 v140, v135
    v_lshrrev_b32 v130, 3, v130
    v_mov_b32 v137, 0x41300000
    v_max_f32 v138, v138, v134
    v_max_f32 v140, v140, v135
    v_add_f32 v138, v137, v138
    v_add_f32 v140, v137, v140
    v_sub_f32 v64, 0, v138
    v_sub_f32 v80, 0, v140
    v_mov_b64 v[32:33], 0
    v_sub_f32 v65, 0, v138
    v_sub_f32 v81, 0, v140
    v_mov_b64 v[34:35], 0
    v_sub_f32 v66, 0, v138
    v_sub_f32 v82, 0, v140
    v_mov_b64 v[36:37], 0
    v_sub_f32 v67, 0, v138
    v_sub_f32 v83, 0, v140
    v_mov_b64 v[38:39], 0
    v_sub_f32 v68, 0, v138
    v_sub_f32 v84, 0, v140
    v_mov_b64 v[40:41], 0
    v_sub_f32 v69, 0, v138
    v_sub_f32 v85, 0, v140
    v_mov_b64 v[42:43], 0
    v_sub_f32 v70, 0, v138
    v_sub_f32 v86, 0, v140
    v_mov_b64 v[44:45], 0
    v_sub_f32 v71, 0, v138
    v_sub_f32 v87, 0, v140
    v_mov_b64 v[46:47], 0
    v_sub_f32 v72, 0, v138
    v_sub_f32 v88, 0, v140
    v_mov_b64 v[48:49], 0
    v_sub_f32 v73, 0, v138
    v_sub_f32 v89, 0, v140
    v_mov_b64 v[50:51], 0
    v_sub_f32 v74, 0, v138
    v_sub_f32 v90, 0, v140
    v_mov_b64 v[52:53], 0
    v_sub_f32 v75, 0, v138
    v_sub_f32 v91, 0, v140
    v_mov_b64 v[54:55], 0
    v_sub_f32 v76, 0, v138
    v_sub_f32 v92, 0, v140
    v_mov_b64 v[56:57], 0
    v_sub_f32 v77, 0, v138
    v_sub_f32 v93, 0, v140
    v_mov_b64 v[58:59], 0
    v_sub_f32 v78, 0, v138
    v_sub_f32 v94, 0, v140
    v_mov_b64 v[60:61], 0
    v_sub_f32 v79, 0, v138
    v_sub_f32 v95, 0, v140
    v_mov_b64 v[62:63], 0
    s_mov_b32 s36, 64
L_slow:
    ds_read_b128 v[104:107], v128
    ds_read_b64_tr_b16 v[112:113], v129 offset:0
    ds_read_b64_tr_b16 v[114:115], v129 offset:128
    ds_read_b64_tr_b16 v[116:117], v129 offset:512
    ds_read_b64_tr_b16 v[118:119], v129 offset:640
    v_add_u32 v128, 1024, v128
    v_add_u32 v129, v130, v129
    s_sub_u32 s36, s36, 1
    s_waitcnt lgkmcnt(0)
    v_mfma_f32_32x32x16_bf16 v[0:15], v[104:107], v[96:99], v[64:79]
    v_mfma_f32_32x32x16_bf16 v[16:31], v[104:107], v[100:103], v[80:95]
    s_nop 11
    v_exp_f32 v0, v0
    v_exp_f32 v1, v1
    v_exp_f32 v2, v2
    v_exp_f32 v3, v3
    v_exp_f32 v4, v4
    v_exp_f32 v5, v5
    v_exp_f32 v6, v6
    v_exp_f32 v7, v7
    v_exp_f32 v8, v8
    v_exp_f32 v9, v9
    v_exp_f32 v10, v10
    v_exp_f32 v11, v11
    v_exp_f32 v12, v12
    v_exp_f32 v13, v13
    v_exp_f32 v14, v14
    v_exp_f32 v15, v15
    v_exp_f32 v16, v16
    v_exp_f32 v17, v17
    v_exp_f32 v18, v18
    v_exp_f32 v19, v19
    v_exp_f32 v20, v20
    v_exp_f32 v21, v21
    v_exp_f32 v22, v22
    v_exp_f32 v23, v23
    v_exp_f32 v24, v24
    v_exp_f32 v25, v25
    v_exp_f32 v26, v26
    v_exp_f32 v27, v27
    v_exp_f32 v28, v28
    v_exp_f32 v29, v29
    v_exp_f32 v30, v30
    v_exp_f32 v31, v31
    s_nop 1
    v_smfmac_f32_32x32x32_bf16 v[32:47], v[112:115], v[0:7], v133
    v_smfmac_f32_32x32x32_bf16 v[48:63], v[112:115], v[16:23], v133
    v_smfmac_f32_32x32x32_bf16 v[32:47], v[116:119], v[8:15], v133
    v_smfmac_f32_32x32x32_bf16 v[48:63], v[116:119], v[24:31], v133
    s_nop 15
    s_cmp_lg_u32 s36, 0
    s_cbranch_scc1 L_slow
    v_rcp_f32 v138, v40
    s_branch L_epi
.section .rodata,"a"
.p2align 6
.amdhsa_kernel standalone__fused_io_aware_attn__prompt_kernel
  .amdhsa_next_free_vgpr 144
  .amdhsa_next_free_sgpr 40
  .amdhsa_accum_offset 144
  .amdhsa_group_segment_fixed_size 0
  .amdhsa_kernarg_size 48
  .amdhsa_user_sgpr_count 2
  .amdhsa_user_sgpr_kernarg_segment_ptr 1
  .amdhsa_system_sgpr_workgroup_id_x 1
.end_amdhsa_kernel
```
